```python
import torch

def _softmax(x, axis=-1):
    return torch.softmax(x, dim=axis)
def _gelu(x):
    return torch.nn.functional.gelu(x, approximate="tanh")
def _silu(x):
    return torch.nn.functional.silu(x)
def _sigmoid(x):
    return torch.sigmoid(x)
def _layernorm(x, axis=-1, eps=1e-5):
    m = x.mean(dim=axis, keepdim=True)
    v = x.var(dim=axis, keepdim=True, unbiased=False)
    return (x - m) / torch.sqrt(v + eps)
def _scatter_add(tgt, idx, src, axis=0):
    return tgt.clone().index_add_(axis, idx, src)
def _segment_sum(src, seg, n):
    out = torch.zeros((n,) + src.shape[1:], dtype=src.dtype)
    return out.index_add_(0, seg, src)
def _pad(x, pw):
    flat = tuple(v for pair in reversed(pw) for v in pair)
    return torch.nn.functional.pad(x, flat)

kernel_name = 'standalone__sliding_block_cached__sampling'

def setup_inputs():

    _w = (lambda a: (lambda t: t.to(torch.bfloat16) if t.is_floating_point() else t)(torch.as_tensor(a)))
    B, Sq, D = 8, 16, 576
    Hq, Hkv, Sk, Dh = 32, 16, 8192, 128
    assert Hq % Hkv == 0, (Hq, Hkv)
    return {
        "x": _w((lambda *s: torch.randn(*s, dtype=torch.bfloat16) * 0.8)(B, Sq, D)),
        "k_cache": _w((lambda *s: torch.randn(*s, dtype=torch.bfloat16) * 0.8)(B, Hkv, Sk, Dh)),
        "v_cache": _w((lambda *s: torch.randn(*s, dtype=torch.bfloat16) * 0.05)(B, Hkv, Sk, Dh)),
        "wq": _w((lambda *s: torch.randn(*s, dtype=torch.bfloat16) * 0.8)(D, Hq * Dh) * (D ** -0.5)),
        "wo": _w((lambda *s: torch.randn(*s, dtype=torch.bfloat16) * 0.05)(Hq * Dh, D) * ((Hq * Dh) ** -0.5)),
    }

def reference(x, k_cache, v_cache, wq, wo):
    B, Sq, D = x.shape
    Hq, Dh = 32, 128
    Hkv, Sk = k_cache.shape[1], k_cache.shape[2]
    W = min(4096, max(256, Sk // 4))
    rep = Hq // Hkv
    q = (lambda x, *d: x.permute(*d))((x @ wq).reshape(B, Sq, Hq, Dh), 0, 2, 1, 3)
    k = (lambda x, n, axis: torch.repeat_interleave(x, n, dim=axis))(k_cache[:, :, Sk - W:, :], rep, axis=1)
    v = (lambda x, n, axis: torch.repeat_interleave(x, n, dim=axis))(v_cache[:, :, Sk - W:, :], rep, axis=1)
    scores = torch.einsum("bhqd,bhkd->bhqk", q, k) * (Dh ** -0.5)
    p = _softmax(scores, axis=-1)
    o = torch.einsum("bhqk,bhkd->bhqd", p, v)
    return (lambda x, *d: x.permute(*d))(o, 0, 2, 1, 3).reshape(B, Sq, Hq * Dh) @ wo
```

```asm
; @launch grid=(256,1,1) block=(256,1,1) lds=163840
.amdgcn_target "amdgcn-amd-amdhsa--gfx950"
.text
.globl standalone__sliding_block_cached__sampling_kernel
.p2align 8
.type standalone__sliding_block_cached__sampling_kernel,@function
standalone__sliding_block_cached__sampling_kernel:
    s_cmp_ge_u32 s2, 256
    s_cbranch_scc1 L_end
    s_load_dwordx16 s[32:47], s[0:1], 0
    v_lshrrev_b32 v1, 6, v0
    s_and_b32 s28, s2, 7
    s_lshr_b32 s29, s2, 3
    v_readfirstlane_b32 s3, v1
    v_and_b32 v0, 63, v0
    s_lshr_b32 s30, s29, 2
    s_and_b32 s48, s29, 3
    s_and_b32 s52, s29, 1
    s_lshl_b32 s31, s28, 1
    s_or_b32 s31, s31, s52
    s_lshl_b32 s49, s28, 5
    s_or_b32 s49, s49, s29
    s_lshl_b32 s50, s3, 12
    s_lshl_b32 s52, s30, 4
    s_or_b32 s52, s52, s31
    s_lshl_b32 s62, s52, 2
    s_add_u32 s62, s62, s3
    s_lshl_b32 s62, s62, 11
    s_lshl_b32 s52, s52, 21
    s_lshr_b32 s53, s29, 1
    s_and_b32 s53, s53, 1
    s_lshl_b32 s53, s53, 18
    s_add_u32 s52, s52, s53
    s_add_u32 s52, s52, 1572864
    s_add_u32 s52, s52, s50
    v_lshrrev_b32 v17, 4, v0
    v_and_b32 v18, 15, v0
    v_lshlrev_b32 v19, 8, v17
    v_add_u32 v20, 0, v17
    v_xor_b32 v20, v20, v18
    v_lshl_add_u32 v1, v20, 4, v19
    v_add_u32 v20, 4, v17
    v_xor_b32 v20, v20, v18
    v_lshl_add_u32 v2, v20, 4, v19
    v_add_u32 v20, 8, v17
    v_xor_b32 v20, v20, v18
    v_lshl_add_u32 v3, v20, 4, v19
    v_add_u32 v20, 12, v17
    v_xor_b32 v20, v20, v18
    v_lshl_add_u32 v4, v20, 4, v19
    v_lshlrev_b32 v20, 2, v17
    v_xor_b32 v20, v20, v18
    v_lshl_add_u32 v5, v20, 4, v19
    s_waitcnt lgkmcnt(0)
    s_add_u32 s4, s34, s52
    s_addc_u32 s5, s35, 0
    s_sub_u32 s6, 262144, s50
    s_mov_b32 s7, 0x20000
    s_add_u32 m0, s50, 0
    s_mov_b32 s51, 0
    buffer_load_dwordx4 v1, s[4:7], s51 offen offset:0 nt lds
    buffer_load_dwordx4 v2, s[4:7], s51 offen offset:1024 nt lds
    buffer_load_dwordx4 v3, s[4:7], s51 offen offset:2048 nt lds
    buffer_load_dwordx4 v4, s[4:7], s51 offen offset:3072 nt lds
    s_lshr_b32 s53, s29, 3
    s_lshl_b32 s53, s53, 8
    s_load_dword s24, s[46:47], s53
    s_lshl_b32 s54, s28, 3
    s_and_b32 s55, s29, 7
    s_or_b32 s54, s54, s55
    s_lshl_b32 s54, s54, 7
    s_lshl_b32 s55, s3, 17
    s_add_u32 s60, s54, s55
    s_lshr_b32 s54, s29, 3
    s_lshl_b32 s54, s54, 2
    s_add_u32 s54, s54, s3
    s_mul_i32 s61, s54, 9216
    v_lshrrev_b32 v17, 3, v0
    v_and_b32 v18, 7, v0
    v_bfe_u32 v19, v0, 4, 1
    v_lshlrev_b32 v19, 2, v19
    v_xor_b32 v19, v19, v18
    v_lshlrev_b32 v19, 4, v19
    v_lshl_add_u32 v24, v17, 13, v19
    s_lshl_b32 s54, s3, 2
    s_and_b32 s54, s54, 4
    v_lshrrev_b32 v19, 4, v0
    v_add_u32 v19, s54, v19
    v_xor_b32 v19, v19, v18
    v_lshlrev_b32 v19, 4, v19
    v_mul_u32_u24 v17, 1152, v17
    v_add_u32 v25, v17, v19
    s_lshr_b32 s25, s29, 3
    s_mul_i32 s25, s25, 2
    s_add_u32 s25, s25, s28
    s_sub_u32 s54, s25, 9
    s_cmp_ge_u32 s25, 9
    s_cselect_b32 s25, s54, s25
    s_add_u32 s16, s38, s60
    s_addc_u32 s17, s39, 0
    s_sub_u32 s18, 4718592, s60
    s_mov_b32 s19, 0x20000
    s_add_u32 s20, s32, s61
    s_addc_u32 s21, s33, 0
    s_sub_u32 s22, 147456, s61
    s_mov_b32 s23, 0x20000
    s_add_u32 s8, s36, s52
    s_addc_u32 s9, s37, 0
    s_mov_b32 s10, s6
    s_mov_b32 s11, 0x20000
    s_lshl_b32 s60, s3, 11
    s_lshl_b32 s61, s3, 10
    s_add_u32 s61, s61, 8192
    s_add_u32 m0, s60, 16384
    s_lshl_b32 s51, s25, 19
    buffer_load_dwordx4 v24, s[16:19], s51 offen  lds
    s_add_u32 m0, s60, 17408
    s_add_u32 s51, s51, 65536
    buffer_load_dwordx4 v24, s[16:19], s51 offen  lds
    s_add_u32 m0, s61, 16384
    s_lshl_b32 s51, s25, 7
    buffer_load_dwordx4 v25, s[20:23], s51 offen  lds
    s_add_u32 s25, s25, 1
    s_cmp_eq_u32 s25, 9
    s_cselect_b32 s25, 0, s25
    s_add_u32 m0, s60, 32768
    s_lshl_b32 s51, s25, 19
    buffer_load_dwordx4 v24, s[16:19], s51 offen  lds
    s_add_u32 m0, s60, 33792
    s_add_u32 s51, s51, 65536
    buffer_load_dwordx4 v24, s[16:19], s51 offen  lds
    s_add_u32 m0, s61, 32768
    s_lshl_b32 s51, s25, 7
    buffer_load_dwordx4 v25, s[20:23], s51 offen  lds
    s_add_u32 s25, s25, 1
    s_cmp_eq_u32 s25, 9
    s_cselect_b32 s25, 0, s25
    s_add_u32 m0, s50, 49152
    s_mov_b32 s51, 16384
    buffer_load_dwordx4 v1, s[4:7], s51 offen offset:0 nt lds
    buffer_load_dwordx4 v2, s[4:7], s51 offen offset:1024 nt lds
    buffer_load_dwordx4 v3, s[4:7], s51 offen offset:2048 nt lds
    buffer_load_dwordx4 v4, s[4:7], s51 offen offset:3072 nt lds
    s_getreg_b32 s26, hwreg(HW_REG_XCC_ID)
    s_and_b32 s26, s26, 15
    s_mul_i32 s57, s49, 23552
    s_add_u32 s57, s57, 1376256
    s_andn2_b32 s63, s49, 3
    s_mul_i32 s63, s63, 23552
    s_add_u32 s63, s63, 1376256
    v_lshlrev_b32 v8, 4, v0
    v_mov_b32 v16, 0
    s_and_b32 s52, s3, 1
    s_lshr_b32 s53, s3, 1
    v_lshrrev_b32 v17, 5, v0
    v_bfe_u32 v20, v0, 4, 1
    v_lshlrev_b32 v20, 1, v20
    v_and_b32 v18, 1, v0
    v_add_u32 v20, v20, v18
    s_lshl_b32 s54, s52, 2
    v_add_u32 v20, s54, v20
    v_bfe_u32 v18, v0, 3, 1
    v_lshlrev_b32 v18, 2, v18
    v_xor_b32 v20, v20, v18
    v_lshlrev_b32 v20, 4, v20
    v_bfe_u32 v18, v0, 1, 1
    v_lshl_add_u32 v20, v18, 3, v20
    v_bfe_u32 v19, v0, 2, 2
    v_lshl_add_u32 v19, v17, 3, v19
    v_lshl_add_u32 v19, v19, 7, v20
    s_lshl_b32 s54, s53, 12
    v_add_u32 v22, s54, v19
    v_bfe_u32 v18, v0, 1, 3
    v_xor_b32 v18, v18, v17
    s_lshl_b32 s54, s53, 2
    v_xor_b32 v18, s54, v18
    v_lshlrev_b32 v18, 4, v18
    v_and_b32 v19, 31, v0
    v_lshl_add_u32 v18, v19, 7, v18
    v_add_u32 v23, 8192, v18
    s_lshr_b32 s54, s29, 3
    s_lshl_b32 s54, s54, 5
    s_lshl_b32 s55, s28, 1
    s_add_u32 s54, s54, s55
    s_bfe_u32 s55, s29, 0x10002
    s_add_u32 s54, s54, s55
    s_lshl_b32 s54, s54, 3
    s_and_b32 s55, s29, 1
    s_lshl_b32 s55, s55, 2
    s_add_u32 s54, s54, s55
    s_lshl_b32 s55, s52, 1
    s_add_u32 s54, s54, s55
    s_add_u32 s54, s54, s53
    s_lshl_b32 s54, s54, 10
    s_and_b32 s55, s29, 2
    s_lshl_b32 s55, s55, 7
    s_add_u32 s54, s54, s55
    v_bfe_u32 v18, v0, 4, 1
    v_lshlrev_b32 v18, 17, v18
    v_lshl_add_u32 v18, v17, 9, v18
    v_and_b32 v19, 15, v0
    v_lshl_add_u32 v18, v19, 4, v18
    v_add_u32 v38, s54, v18
    v_xor_b32 v18, v19, v17
    v_lshlrev_b32 v18, 4, v18
    v_and_b32 v19, 31, v0
    v_lshl_add_u32 v18, v19, 8, v18
    s_lshl_b32 s54, s52, 13
    v_add_u32 v6, s54, v18
    v_min_u32 v18, 39, v0
    v_lshlrev_b32 v31, 4, v18
    s_xor_b32 s54, s48, 2
    v_and_b32 v18, 3, v0
    v_mov_b32 v20, s54
    v_cmp_gt_u32 vcc, 32, v0
    s_mov_b32 s55, 23552
    s_nop 0
    v_cndmask_b32 v18, v18, v20, vcc
    v_mul_lo_u32 v18, v18, s55
    v_min_u32 v20, 512, v31
    v_add_u32 v26, v18, v20
    v_lshlrev_b32 v19, 2, v19
    v_add_u32 v30, 155648, v19
    s_lshl_b32 s54, s3, 7
    v_add_u32 v29, s54, v30
    v_bfe_u32 v19, v0, 4, 1
    v_lshlrev_b32 v19, 1, v19
    v_bfe_u32 v18, v0, 1, 1
    v_add_u32 v19, v19, v18
    s_lshl_b32 s54, s3, 2
    v_add_u32 v19, s54, v19
    v_bfe_u32 v18, v0, 2, 2
    v_lshlrev_b32 v20, 2, v18
    v_xor_b32 v19, v19, v20
    v_lshlrev_b32 v19, 4, v19
    v_and_b32 v20, 1, v0
    v_lshl_add_u32 v19, v20, 3, v19
    v_lshl_add_u32 v18, v17, 2, v18
    v_lshl_add_u32 v7, v18, 8, v19
    s_lshl_b32 s54, s52, 11
    s_add_u32 s54, s54, 147456
    v_add_u32 v27, s54, v8
    v_add_u32 v28, 147456, v8
    s_mov_b32 s56, 0x3e0293ee
    v_mov_b32 v9, 0xff800000
    v_mov_b32 v11, 0
    v_mov_b32 v12, 0
    v_bfe_u32 v18, v0, 1, 3
    v_mul_u32_u24 v18, 1152, v18
    v_lshrrev_b32 v19, 4, v0
    v_lshl_add_u32 v18, v19, 5, v18
    v_lshl_add_u32 v18, v20, 4, v18
    s_lshl_b32 s54, s48, 8
    v_add_u32 v37, s54, v18
    s_mul_i32 s27, s48, 36608
    s_add_u32 s27, s27, 1024
    v_and_b32 v18, 15, v0
    v_lshlrev_b32 v18, 3, v18
    v_bfe_u32 v19, v0, 4, 1
    v_lshl_add_u32 v18, v19, 7, v18
    v_lshl_add_u32 v18, v17, 11, v18
    s_and_b32 s54, s48, 1
    s_lshl_b32 s54, s54, 13
    s_lshl_b32 s55, s3, 8
    s_add_u32 s54, s54, s55
    v_add_u32 v39, s54, v18
    v_and_b32 v18, 15, v0
    v_lshl_add_u32 v18, v19, 5, v18
    v_lshlrev_b32 v18, 4, v18
    v_lshl_add_u32 v18, v17, 10, v18
    v_mov_b32 v32, v18
    v_bfe_u32 v18, v0, 1, 3
    v_mul_u32_u24 v18, 1536, v18
    v_lshl_add_u32 v18, v20, 6, v18
    v_lshrrev_b32 v19, 4, v0
    v_lshl_add_u32 v35, v19, 4, v18
    s_waitcnt lgkmcnt(0)
    s_add_u32 s24, s24, 1
    s_mov_b32 s12, s46
    s_mov_b32 s13, s47
    s_mov_b32 s14, 7471104
    s_mov_b32 s15, 0x20000
    v_mov_b32 v14, s24
    v_mov_b32 v41, s24
    v_mov_b32 v43, s24
    s_cmp_lg_u32 s3, 0
    s_cbranch_scc1 L_notabs
    v_mov_b32 v40, s26
    s_lshl_b32 s54, s49, 4
    s_add_u32 s54, s54, 4096
    buffer_store_dwordx2 v[40:41], v16, s[12:15], s54 offen sc1
L_notabs:
    s_waitcnt vmcnt(10)
    s_barrier
    s_add_u32 m0, s60, 65536
    s_lshl_b32 s51, s25, 19
    buffer_load_dwordx4 v24, s[16:19], s51 offen  lds
    s_add_u32 m0, s60, 66560
    s_add_u32 s51, s51, 65536
    buffer_load_dwordx4 v24, s[16:19], s51 offen  lds
    s_add_u32 m0, s61, 65536
    s_lshl_b32 s51, s25, 7
    buffer_load_dwordx4 v25, s[20:23], s51 offen  lds
    s_add_u32 s25, s25, 1
    s_cmp_eq_u32 s25, 9
    s_cselect_b32 s25, 0, s25
    s_cmp_ge_u32 s3, 2
    s_cbranch_scc1 L_kr_1
    v_add_u32 v17, 0, v6
    ds_read_b128 a[0:3], v17
    v_xor_b32 v18, 32, v17
    ds_read_b128 a[4:7], v18
    v_xor_b32 v19, 64, v17
    ds_read_b128 a[8:11], v19
    v_xor_b32 v18, 96, v17
    ds_read_b128 a[12:15], v18
    v_xor_b32 v19, 128, v17
    ds_read_b128 a[16:19], v19
    v_xor_b32 v18, 160, v17
    ds_read_b128 a[20:23], v18
    v_xor_b32 v19, 192, v17
    ds_read_b128 a[24:27], v19
    v_xor_b32 v18, 224, v17
    ds_read_b128 a[28:31], v18
L_kr_1:
    s_waitcnt lgkmcnt(0)
    s_waitcnt vmcnt(10)
    s_barrier
    s_add_u32 m0, s60, 81920
    s_lshl_b32 s51, s25, 19
    buffer_load_dwordx4 v24, s[16:19], s51 offen  lds
    s_add_u32 m0, s60, 82944
    s_add_u32 s51, s51, 65536
    buffer_load_dwordx4 v24, s[16:19], s51 offen  lds
    s_add_u32 m0, s61, 81920
    s_lshl_b32 s51, s25, 7
    buffer_load_dwordx4 v25, s[20:23], s51 offen  lds
    s_add_u32 s25, s25, 1
    s_cmp_eq_u32 s25, 9
    s_cselect_b32 s25, 0, s25
    v_add_u32 v17, 16384, v22
    v_add_u32 v18, 16384, v23
    v_xor_b32 v19, 32, v18
    ds_read_b64_tr_b16 v[48:49], v17 offset:0
    ds_read_b64_tr_b16 v[50:51], v17 offset:512
    ds_read_b128 v[52:55], v18
    ds_read_b64_tr_b16 v[56:57], v17 offset:2048
    ds_read_b64_tr_b16 v[58:59], v17 offset:2560
    ds_read_b128 v[60:63], v19
    s_waitcnt lgkmcnt(3)
    v_mfma_f32_32x32x16_bf16 v[80:95], v[48:51], v[52:55], 0
    s_waitcnt lgkmcnt(0)
    v_mfma_f32_32x32x16_bf16 v[80:95], v[56:59], v[60:63], v[80:95]
    s_waitcnt lgkmcnt(0)
    s_waitcnt vmcnt(10)
    s_barrier
    s_add_u32 m0, s50, 98304
    s_mov_b32 s51, 32768
    buffer_load_dwordx4 v1, s[4:7], s51 offen offset:0 nt lds
    buffer_load_dwordx4 v2, s[4:7], s51 offen offset:1024 nt lds
    buffer_load_dwordx4 v3, s[4:7], s51 offen offset:2048 nt lds
    buffer_load_dwordx4 v4, s[4:7], s51 offen offset:3072 nt lds
    v_add_u32 v17, 32768, v22
    v_add_u32 v18, 32768, v23
    v_xor_b32 v19, 32, v18
    ds_read_b64_tr_b16 v[48:49], v17 offset:0
    ds_read_b64_tr_b16 v[50:51], v17 offset:512
    ds_read_b128 v[52:55], v18
    ds_read_b64_tr_b16 v[56:57], v17 offset:2048
    ds_read_b64_tr_b16 v[58:59], v17 offset:2560
    ds_read_b128 v[60:63], v19
    s_waitcnt lgkmcnt(3)
    v_mfma_f32_32x32x16_bf16 v[80:95], v[48:51], v[52:55], v[80:95]
    s_waitcnt lgkmcnt(0)
    v_mfma_f32_32x32x16_bf16 v[80:95], v[56:59], v[60:63], v[80:95]
    s_waitcnt lgkmcnt(0)
    s_waitcnt vmcnt(10)
    s_barrier
    s_add_u32 m0, s60, 114688
    s_lshl_b32 s51, s25, 19
    buffer_load_dwordx4 v24, s[16:19], s51 offen  lds
    s_add_u32 m0, s60, 115712
    s_add_u32 s51, s51, 65536
    buffer_load_dwordx4 v24, s[16:19], s51 offen  lds
    s_add_u32 m0, s61, 114688
    s_lshl_b32 s51, s25, 7
    buffer_load_dwordx4 v25, s[20:23], s51 offen  lds
    s_add_u32 s25, s25, 1
    s_cmp_eq_u32 s25, 9
    s_cselect_b32 s25, 0, s25
    s_cmp_lt_u32 s3, 2
    s_cbranch_scc1 L_kr_2
    v_add_u32 v17, 49152, v6
    ds_read_b128 a[0:3], v17
    v_xor_b32 v18, 32, v17
    ds_read_b128 a[4:7], v18
    v_xor_b32 v19, 64, v17
    ds_read_b128 a[8:11], v19
    v_xor_b32 v18, 96, v17
    ds_read_b128 a[12:15], v18
    v_xor_b32 v19, 128, v17
    ds_read_b128 a[16:19], v19
    v_xor_b32 v18, 160, v17
    ds_read_b128 a[20:23], v18
    v_xor_b32 v19, 192, v17
    ds_read_b128 a[24:27], v19
    v_xor_b32 v18, 224, v17
    ds_read_b128 a[28:31], v18
L_kr_2:
    s_waitcnt lgkmcnt(0)
    s_waitcnt vmcnt(10)
    s_barrier
    s_andn2_b32 s52, s49, 7
    s_lshl_b32 s52, s52, 4
    s_add_u32 s52, s52, 4096
    v_and_b32 v17, 7, v0
    v_lshlrev_b32 v17, 4, v17
    buffer_load_dwordx2 v[44:45], v17, s[12:15], s52 offen sc1
    s_add_u32 m0, s60, 131072
    s_lshl_b32 s51, s25, 19
    buffer_load_dwordx4 v24, s[16:19], s51 offen  lds
    s_add_u32 m0, s60, 132096
    s_add_u32 s51, s51, 65536
    buffer_load_dwordx4 v24, s[16:19], s51 offen  lds
    s_add_u32 m0, s61, 131072
    s_lshl_b32 s51, s25, 7
    buffer_load_dwordx4 v25, s[20:23], s51 offen  lds
    s_add_u32 s25, s25, 1
    s_cmp_eq_u32 s25, 9
    s_cselect_b32 s25, 0, s25
    v_add_u32 v17, 65536, v22
    v_add_u32 v18, 65536, v23
    v_xor_b32 v19, 32, v18
    ds_read_b64_tr_b16 v[48:49], v17 offset:0
    ds_read_b64_tr_b16 v[50:51], v17 offset:512
    ds_read_b128 v[52:55], v18
    ds_read_b64_tr_b16 v[56:57], v17 offset:2048
    ds_read_b64_tr_b16 v[58:59], v17 offset:2560
    ds_read_b128 v[60:63], v19
    s_waitcnt lgkmcnt(3)
    v_mfma_f32_32x32x16_bf16 v[80:95], v[48:51], v[52:55], v[80:95]
    s_waitcnt lgkmcnt(0)
    v_mfma_f32_32x32x16_bf16 v[80:95], v[56:59], v[60:63], v[80:95]
    s_waitcnt lgkmcnt(0)
    s_waitcnt vmcnt(11)
    s_barrier
    s_add_u32 m0, s50, 0
    s_mov_b32 s51, 49152
    buffer_load_dwordx4 v1, s[4:7], s51 offen offset:0 nt lds
    buffer_load_dwordx4 v2, s[4:7], s51 offen offset:1024 nt lds
    buffer_load_dwordx4 v3, s[4:7], s51 offen offset:2048 nt lds
    buffer_load_dwordx4 v4, s[4:7], s51 offen offset:3072 nt lds
    v_add_u32 v17, 81920, v22
    v_add_u32 v18, 81920, v23
    v_xor_b32 v19, 32, v18
    ds_read_b64_tr_b16 v[48:49], v17 offset:0
    ds_read_b64_tr_b16 v[50:51], v17 offset:512
    ds_read_b128 v[52:55], v18
    ds_read_b64_tr_b16 v[56:57], v17 offset:2048
    ds_read_b64_tr_b16 v[58:59], v17 offset:2560
    ds_read_b128 v[60:63], v19
    s_waitcnt lgkmcnt(3)
    v_mfma_f32_32x32x16_bf16 v[80:95], v[48:51], v[52:55], v[80:95]
    s_waitcnt lgkmcnt(0)
    v_mfma_f32_32x32x16_bf16 v[80:95], v[56:59], v[60:63], v[80:95]
    s_waitcnt lgkmcnt(0)
    s_waitcnt vmcnt(11)
    s_barrier
    s_add_u32 m0, s60, 16384
    s_lshl_b32 s51, s25, 19
    buffer_load_dwordx4 v24, s[16:19], s51 offen  lds
    s_add_u32 m0, s60, 17408
    s_add_u32 s51, s51, 65536
    buffer_load_dwordx4 v24, s[16:19], s51 offen  lds
    s_add_u32 m0, s61, 16384
    s_lshl_b32 s51, s25, 7
    buffer_load_dwordx4 v25, s[20:23], s51 offen  lds
    s_add_u32 s25, s25, 1
    s_cmp_eq_u32 s25, 9
    s_cselect_b32 s25, 0, s25
    s_cmp_ge_u32 s3, 2
    s_cbranch_scc1 L_kr_3
    v_add_u32 v17, 98304, v6
    ds_read_b128 a[32:35], v17
    v_xor_b32 v18, 32, v17
    ds_read_b128 a[36:39], v18
    v_xor_b32 v19, 64, v17
    ds_read_b128 a[40:43], v19
    v_xor_b32 v18, 96, v17
    ds_read_b128 a[44:47], v18
    v_xor_b32 v19, 128, v17
    ds_read_b128 a[48:51], v19
    v_xor_b32 v18, 160, v17
    ds_read_b128 a[52:55], v18
    v_xor_b32 v19, 192, v17
    ds_read_b128 a[56:59], v19
    v_xor_b32 v18, 224, v17
    ds_read_b128 a[60:63], v18
L_kr_3:
    s_waitcnt lgkmcnt(0)
    s_waitcnt vmcnt(11)
    s_barrier
    s_add_u32 m0, s60, 32768
    s_lshl_b32 s51, s25, 19
    buffer_load_dwordx4 v24, s[16:19], s51 offen  lds
    s_add_u32 m0, s60, 33792
    s_add_u32 s51, s51, 65536
    buffer_load_dwordx4 v24, s[16:19], s51 offen  lds
    s_add_u32 m0, s61, 32768
    s_lshl_b32 s51, s25, 7
    buffer_load_dwordx4 v25, s[20:23], s51 offen  lds
    s_add_u32 s25, s25, 1
    s_cmp_eq_u32 s25, 9
    s_cselect_b32 s25, 0, s25
    v_add_u32 v17, 114688, v22
    v_add_u32 v18, 114688, v23
    v_xor_b32 v19, 32, v18
    ds_read_b64_tr_b16 v[48:49], v17 offset:0
    ds_read_b64_tr_b16 v[50:51], v17 offset:512
    ds_read_b128 v[52:55], v18
    ds_read_b64_tr_b16 v[56:57], v17 offset:2048
    ds_read_b64_tr_b16 v[58:59], v17 offset:2560
    ds_read_b128 v[60:63], v19
    s_waitcnt lgkmcnt(3)
    v_mfma_f32_32x32x16_bf16 v[80:95], v[48:51], v[52:55], v[80:95]
    s_waitcnt lgkmcnt(0)
    v_mfma_f32_32x32x16_bf16 v[80:95], v[56:59], v[60:63], v[80:95]
    s_waitcnt lgkmcnt(0)
    s_waitcnt vmcnt(10)
    s_barrier
    s_add_u32 m0, s50, 49152
    s_mov_b32 s51, 65536
    buffer_load_dwordx4 v1, s[4:7], s51 offen offset:0 nt lds
    buffer_load_dwordx4 v2, s[4:7], s51 offen offset:1024 nt lds
    buffer_load_dwordx4 v3, s[4:7], s51 offen offset:2048 nt lds
    buffer_load_dwordx4 v4, s[4:7], s51 offen offset:3072 nt lds
    v_add_u32 v17, 131072, v22
    v_add_u32 v18, 131072, v23
    v_xor_b32 v19, 32, v18
    ds_read_b64_tr_b16 v[48:49], v17 offset:0
    ds_read_b64_tr_b16 v[50:51], v17 offset:512
    ds_read_b128 v[52:55], v18
    ds_read_b64_tr_b16 v[56:57], v17 offset:2048
    ds_read_b64_tr_b16 v[58:59], v17 offset:2560
    ds_read_b128 v[60:63], v19
    s_waitcnt lgkmcnt(3)
    v_mfma_f32_32x32x16_bf16 v[80:95], v[48:51], v[52:55], v[80:95]
    s_waitcnt lgkmcnt(0)
    v_mfma_f32_32x32x16_bf16 v[80:95], v[56:59], v[60:63], v[80:95]
    s_waitcnt lgkmcnt(0)
    s_waitcnt vmcnt(10)
    s_barrier
    s_add_u32 m0, s60, 65536
    s_lshl_b32 s51, s25, 19
    buffer_load_dwordx4 v24, s[16:19], s51 offen  lds
    s_add_u32 m0, s60, 66560
    s_add_u32 s51, s51, 65536
    buffer_load_dwordx4 v24, s[16:19], s51 offen  lds
    s_add_u32 m0, s61, 65536
    s_lshl_b32 s51, s25, 7
    buffer_load_dwordx4 v25, s[20:23], s51 offen  lds
    s_cmp_lt_u32 s3, 2
    s_cbranch_scc1 L_kr_4
    v_add_u32 v17, 0, v6
    ds_read_b128 a[32:35], v17
    v_xor_b32 v18, 32, v17
    ds_read_b128 a[36:39], v18
    v_xor_b32 v19, 64, v17
    ds_read_b128 a[40:43], v19
    v_xor_b32 v18, 96, v17
    ds_read_b128 a[44:47], v18
    v_xor_b32 v19, 128, v17
    ds_read_b128 a[48:51], v19
    v_xor_b32 v18, 160, v17
    ds_read_b128 a[52:55], v18
    v_xor_b32 v19, 192, v17
    ds_read_b128 a[56:59], v19
    v_xor_b32 v18, 224, v17
    ds_read_b128 a[60:63], v18
L_kr_4:
    s_waitcnt lgkmcnt(0)
    s_waitcnt vmcnt(10)
    s_barrier
    s_lshl_b32 s52, s28, 2
    s_add_u32 s52, s52, s3
    s_mul_i32 s52, s52, 147456
    s_add_u32 s16, s40, s52
    s_addc_u32 s17, s41, 0
    s_mov_b32 s18, 147456
    s_mov_b32 s20, s42
    s_mov_b32 s21, s43
    s_mov_b32 s22, 147456
    s_add_u32 m0, s50, 81920
    s_mov_b32 s51, 81920
    buffer_load_dwordx4 v1, s[4:7], s51 offen offset:0 nt lds
    buffer_load_dwordx4 v2, s[4:7], s51 offen offset:1024 nt lds
    buffer_load_dwordx4 v3, s[4:7], s51 offen offset:2048 nt lds
    buffer_load_dwordx4 v4, s[4:7], s51 offen offset:3072 nt lds
    v_add_u32 v17, 16384, v22
    v_add_u32 v18, 16384, v23
    v_xor_b32 v19, 32, v18
    ds_read_b64_tr_b16 v[48:49], v17 offset:0
    ds_read_b64_tr_b16 v[50:51], v17 offset:512
    ds_read_b128 v[52:55], v18
    ds_read_b64_tr_b16 v[56:57], v17 offset:2048
    ds_read_b64_tr_b16 v[58:59], v17 offset:2560
    ds_read_b128 v[60:63], v19
    s_waitcnt lgkmcnt(3)
    v_mfma_f32_32x32x16_bf16 v[80:95], v[48:51], v[52:55], v[80:95]
    s_waitcnt lgkmcnt(0)
    v_mfma_f32_32x32x16_bf16 v[80:95], v[56:59], v[60:63], v[80:95]
    s_waitcnt lgkmcnt(0)
    s_waitcnt vmcnt(11)
    s_barrier
    s_add_u32 m0, s50, 98304
    s_mov_b32 s51, 98304
    buffer_load_dwordx4 v1, s[4:7], s51 offen offset:0 nt lds
    buffer_load_dwordx4 v2, s[4:7], s51 offen offset:1024 nt lds
    buffer_load_dwordx4 v3, s[4:7], s51 offen offset:2048 nt lds
    buffer_load_dwordx4 v4, s[4:7], s51 offen offset:3072 nt lds
    v_add_u32 v17, 32768, v22
    v_add_u32 v18, 32768, v23
    v_xor_b32 v19, 32, v18
    ds_read_b64_tr_b16 v[48:49], v17 offset:0
    ds_read_b64_tr_b16 v[50:51], v17 offset:512
    ds_read_b128 v[52:55], v18
    ds_read_b64_tr_b16 v[56:57], v17 offset:2048
    ds_read_b64_tr_b16 v[58:59], v17 offset:2560
    ds_read_b128 v[60:63], v19
    s_waitcnt lgkmcnt(3)
    v_mfma_f32_32x32x16_bf16 v[80:95], v[48:51], v[52:55], v[80:95]
    s_waitcnt lgkmcnt(0)
    v_mfma_f32_32x32x16_bf16 v[80:95], v[56:59], v[60:63], v[80:95]
    s_waitcnt lgkmcnt(0)
    s_waitcnt vmcnt(11)
    s_barrier
    s_add_u32 m0, s50, 114688
    s_mov_b32 s51, 114688
    buffer_load_dwordx4 v1, s[4:7], s51 offen offset:0 nt lds
    buffer_load_dwordx4 v2, s[4:7], s51 offen offset:1024 nt lds
    buffer_load_dwordx4 v3, s[4:7], s51 offen offset:2048 nt lds
    buffer_load_dwordx4 v4, s[4:7], s51 offen offset:3072 nt lds
    s_cmp_ge_u32 s3, 2
    s_cbranch_scc1 L_kr_5
    v_add_u32 v17, 49152, v6
    ds_read_b128 a[64:67], v17
    v_xor_b32 v18, 32, v17
    ds_read_b128 a[68:71], v18
    v_xor_b32 v19, 64, v17
    ds_read_b128 a[72:75], v19
    v_xor_b32 v18, 96, v17
    ds_read_b128 a[76:79], v18
    v_xor_b32 v19, 128, v17
    ds_read_b128 a[80:83], v19
    v_xor_b32 v18, 160, v17
    ds_read_b128 a[84:87], v18
    v_xor_b32 v19, 192, v17
    ds_read_b128 a[88:91], v19
    v_xor_b32 v18, 224, v17
    ds_read_b128 a[92:95], v18
L_kr_5:
    s_waitcnt lgkmcnt(0)
    s_waitcnt vmcnt(12)
    s_barrier
    s_add_u32 m0, s50, 131072
    s_mov_b32 s51, 131072
    buffer_load_dwordx4 v1, s[4:7], s51 offen offset:0 nt lds
    buffer_load_dwordx4 v2, s[4:7], s51 offen offset:1024 nt lds
    buffer_load_dwordx4 v3, s[4:7], s51 offen offset:2048 nt lds
    buffer_load_dwordx4 v4, s[4:7], s51 offen offset:3072 nt lds
    v_add_u32 v17, 65536, v22
    v_add_u32 v18, 65536, v23
    v_xor_b32 v19, 32, v18
    ds_read_b64_tr_b16 v[48:49], v17 offset:0
    ds_read_b64_tr_b16 v[50:51], v17 offset:512
    ds_read_b128 v[52:55], v18
    ds_read_b64_tr_b16 v[56:57], v17 offset:2048
    ds_read_b64_tr_b16 v[58:59], v17 offset:2560
    ds_read_b128 v[60:63], v19
    s_waitcnt lgkmcnt(3)
    v_mfma_f32_32x32x16_bf16 v[80:95], v[48:51], v[52:55], v[80:95]
    s_waitcnt lgkmcnt(0)
    v_mfma_f32_32x32x16_bf16 v[80:95], v[56:59], v[60:63], v[80:95]
    s_lshl_b32 s52, s3, 11
    s_add_u32 s52, s52, 147456
    v_add_u32 v17, s52, v8
    s_nop 7
    s_cmp_ge_u32 s3, 2
    s_cbranch_scc1 L_qx_6
    ds_write_b128 v17, v[88:91]
    ds_write_b128 v17, v[92:95] offset:1024
    s_branch L_qx_7
L_qx_6:
    ds_write_b128 v17, v[80:83]
    ds_write_b128 v17, v[84:87] offset:1024
    s_nop 1
    v_mov_b32 v80, v88
    v_mov_b32 v81, v89
    v_mov_b32 v82, v90
    v_mov_b32 v83, v91
    v_mov_b32 v84, v92
    v_mov_b32 v85, v93
    v_mov_b32 v86, v94
    v_mov_b32 v87, v95
L_qx_7:
    s_waitcnt lgkmcnt(0)
    s_waitcnt vmcnt(12)
    s_barrier
    s_xor_b32 s52, s3, 2
    s_lshl_b32 s52, s52, 11
    s_add_u32 s52, s52, 147456
    v_add_u32 v17, s52, v8
    ds_read_b128 v[48:51], v17
    ds_read_b128 v[52:55], v17 offset:1024
    v_xor_b32 v18, s26, v44
    v_bitop3_b32 v18, v18, v45, v14 bitop3:0xf6
    v_cmp_ne_u32 vcc, 0, v18
    s_waitcnt lgkmcnt(0)
    v_add_f32 v48, v48, v80
    v_add_f32 v49, v49, v81
    v_add_f32 v50, v50, v82
    v_add_f32 v51, v51, v83
    v_add_f32 v52, v52, v84
    v_add_f32 v53, v53, v85
    v_add_f32 v54, v54, v86
    v_add_f32 v55, v55, v87
    v_cvt_pk_bf16_f32 v56, v48, v49
    v_cvt_pk_bf16_f32 v57, v50, v51
    v_cvt_pk_bf16_f32 v58, v52, v53
    v_cvt_pk_bf16_f32 v59, v54, v55
    v_alignbit_b32 v18, v57, v57, 5
    v_alignbit_b32 v19, v58, v58, 11
    v_add3_u32 v18, v56, v18, v19
    v_alignbit_b32 v19, v59, v59, 19
    v_add3_u32 v60, v18, v19, v14
    v_lshlrev_b32 v17, 2, v0
    s_lshl_b32 s52, s49, 2
    s_add_u32 s52, s52, s3
    s_lshl_b32 s52, s52, 8
    s_add_u32 s52, s52, 1114112
    s_mov_b32 s53, 65536
    s_or_b32 s58, vcc_lo, vcc_hi
    s_cbranch_vccz L_qs_8
    buffer_store_dwordx4 v[56:59], v38, s[12:15], s53 offen sc1
    buffer_store_dword v60, v17, s[12:15], s52 offen sc1
    s_branch L_qs_9
L_qs_8:
    buffer_store_dwordx4 v[56:59], v38, s[12:15], s53 offen
    buffer_store_dword v60, v17, s[12:15], s52 offen
L_qs_9:
    s_add_u32 m0, s50, 0
    s_mov_b32 s51, 147456
    buffer_load_dwordx4 v1, s[4:7], s51 offen offset:0 nt lds
    buffer_load_dwordx4 v2, s[4:7], s51 offen offset:1024 nt lds
    buffer_load_dwordx4 v3, s[4:7], s51 offen offset:2048 nt lds
    buffer_load_dwordx4 v4, s[4:7], s51 offen offset:3072 nt lds
    s_cmp_lt_u32 s3, 2
    s_cbranch_scc1 L_kr_10
    v_add_u32 v17, 81920, v6
    ds_read_b128 a[64:67], v17
    v_xor_b32 v18, 32, v17
    ds_read_b128 a[68:71], v18
    v_xor_b32 v19, 64, v17
    ds_read_b128 a[72:75], v19
    v_xor_b32 v18, 96, v17
    ds_read_b128 a[76:79], v18
    v_xor_b32 v19, 128, v17
    ds_read_b128 a[80:83], v19
    v_xor_b32 v18, 160, v17
    ds_read_b128 a[84:87], v18
    v_xor_b32 v19, 192, v17
    ds_read_b128 a[88:91], v19
    v_xor_b32 v18, 224, v17
    ds_read_b128 a[92:95], v18
L_kr_10:
    s_waitcnt lgkmcnt(0)
    s_waitcnt vmcnt(14)
    s_barrier
    s_add_u32 m0, s50, 16384
    s_mov_b32 s51, 163840
    buffer_load_dwordx4 v1, s[4:7], s51 offen offset:0 nt lds
    buffer_load_dwordx4 v2, s[4:7], s51 offen offset:1024 nt lds
    buffer_load_dwordx4 v3, s[4:7], s51 offen offset:2048 nt lds
    buffer_load_dwordx4 v4, s[4:7], s51 offen offset:3072 nt lds
    s_cmp_ge_u32 s3, 2
    s_cbranch_scc1 L_kr_11
    v_add_u32 v17, 98304, v6
    ds_read_b128 a[96:99], v17
    v_xor_b32 v18, 32, v17
    ds_read_b128 a[100:103], v18
    v_xor_b32 v19, 64, v17
    ds_read_b128 a[104:107], v19
    v_xor_b32 v18, 96, v17
    ds_read_b128 a[108:111], v18
    v_xor_b32 v19, 128, v17
    ds_read_b128 a[112:115], v19
    v_xor_b32 v18, 160, v17
    ds_read_b128 a[116:119], v18
    v_xor_b32 v19, 192, v17
    ds_read_b128 a[120:123], v19
    v_xor_b32 v18, 224, v17
    ds_read_b128 a[124:127], v18
L_kr_11:
    s_waitcnt lgkmcnt(0)
    s_waitcnt vmcnt(14)
    s_barrier
    s_add_u32 s53, s62, 65536
    s_andn2_b32 s52, s49, 7
    s_and_b32 s54, s29, 1
    s_lshl_b32 s54, s54, 2
    s_add_u32 s52, s52, s54
    s_lshr_b32 s54, s3, 1
    s_add_u32 s52, s52, s54
    s_lshl_b32 s52, s52, 2
    s_and_b32 s54, s3, 1
    s_add_u32 s52, s52, s54
    s_lshl_b32 s52, s52, 8
    s_and_b32 s54, s30, 1
    s_lshl_b32 s54, s54, 6
    s_add_u32 s52, s52, s54
    s_add_u32 s52, s52, 1114112
    v_and_b32 v20, 47, v0
    v_lshlrev_b32 v20, 2, v20
    v_bfe_u32 v21, v0, 4, 1
    v_lshl_add_u32 v20, v21, 11, v20
    buffer_load_dwordx4 v[64:67], v8, s[12:15], s53 offen offset:0 sc1
    buffer_load_dwordx4 v[68:71], v8, s[12:15], s53 offen offset:1024 sc1
    buffer_load_dword v72, v20, s[12:15], s52 offen offset:0 sc1
    buffer_load_dword v73, v20, s[12:15], s52 offen offset:512 sc1
    s_add_u32 m0, s50, 32768
    s_mov_b32 s51, 180224
    buffer_load_dwordx4 v1, s[4:7], s51 offen offset:0 nt lds
    buffer_load_dwordx4 v2, s[4:7], s51 offen offset:1024 nt lds
    buffer_load_dwordx4 v3, s[4:7], s51 offen offset:2048 nt lds
    buffer_load_dwordx4 v4, s[4:7], s51 offen offset:3072 nt lds
    s_cmp_lt_u32 s3, 2
    s_cbranch_scc1 L_kr_12
    v_add_u32 v17, 114688, v6
    ds_read_b128 a[96:99], v17
    v_xor_b32 v18, 32, v17
    ds_read_b128 a[100:103], v18
    v_xor_b32 v19, 64, v17
    ds_read_b128 a[104:107], v19
    v_xor_b32 v18, 96, v17
    ds_read_b128 a[108:111], v18
    v_xor_b32 v19, 128, v17
    ds_read_b128 a[112:115], v19
    v_xor_b32 v18, 160, v17
    ds_read_b128 a[116:119], v18
    v_xor_b32 v19, 192, v17
    ds_read_b128 a[120:123], v19
    v_xor_b32 v18, 224, v17
    ds_read_b128 a[124:127], v18
L_kr_12:
    s_waitcnt lgkmcnt(0)
    s_waitcnt vmcnt(18)
    s_barrier
    s_add_u32 m0, s50, 49152
    s_mov_b32 s51, 196608
    buffer_load_dwordx4 v1, s[4:7], s51 offen offset:0 nt lds
    buffer_load_dwordx4 v2, s[4:7], s51 offen offset:1024 nt lds
    buffer_load_dwordx4 v3, s[4:7], s51 offen offset:2048 nt lds
    buffer_load_dwordx4 v4, s[4:7], s51 offen offset:3072 nt lds
    s_cmp_ge_u32 s3, 2
    s_cbranch_scc1 L_kr_13
    v_add_u32 v17, 131072, v6
    ds_read_b128 a[128:131], v17
    v_xor_b32 v18, 32, v17
    ds_read_b128 a[132:135], v18
    v_xor_b32 v19, 64, v17
    ds_read_b128 a[136:139], v19
    v_xor_b32 v18, 96, v17
    ds_read_b128 a[140:143], v18
    v_xor_b32 v19, 128, v17
    ds_read_b128 a[144:147], v19
    v_xor_b32 v18, 160, v17
    ds_read_b128 a[148:151], v18
    v_xor_b32 v19, 192, v17
    ds_read_b128 a[152:155], v19
    v_xor_b32 v18, 224, v17
    ds_read_b128 a[156:159], v18
L_kr_13:
    s_waitcnt lgkmcnt(0)
    s_waitcnt vmcnt(16)
    s_barrier
    s_add_u32 m0, s50, 65536
    s_mov_b32 s51, 212992
    buffer_load_dwordx4 v1, s[4:7], s51 offen offset:0 nt lds
    buffer_load_dwordx4 v2, s[4:7], s51 offen offset:1024 nt lds
    buffer_load_dwordx4 v3, s[4:7], s51 offen offset:2048 nt lds
    buffer_load_dwordx4 v4, s[4:7], s51 offen offset:3072 nt lds
    s_cmp_lt_u32 s3, 2
    s_cbranch_scc1 L_kr_14
    v_add_u32 v17, 0, v6
    ds_read_b128 a[128:131], v17
    v_xor_b32 v18, 32, v17
    ds_read_b128 a[132:135], v18
    v_xor_b32 v19, 64, v17
    ds_read_b128 a[136:139], v19
    v_xor_b32 v18, 96, v17
    ds_read_b128 a[140:143], v18
    v_xor_b32 v19, 128, v17
    ds_read_b128 a[144:147], v19
    v_xor_b32 v18, 160, v17
    ds_read_b128 a[148:151], v18
    v_xor_b32 v19, 192, v17
    ds_read_b128 a[152:155], v19
    v_xor_b32 v18, 224, v17
    ds_read_b128 a[156:159], v18
L_kr_14:
    s_waitcnt lgkmcnt(0)
    s_waitcnt vmcnt(16)
    s_barrier
    s_add_u32 m0, s50, 81920
    s_mov_b32 s51, 229376
    buffer_load_dwordx4 v1, s[4:7], s51 offen offset:0 nt lds
    buffer_load_dwordx4 v2, s[4:7], s51 offen offset:1024 nt lds
    buffer_load_dwordx4 v3, s[4:7], s51 offen offset:2048 nt lds
    buffer_load_dwordx4 v4, s[4:7], s51 offen offset:3072 nt lds
    s_cmp_ge_u32 s3, 2
    s_cbranch_scc1 L_kr_15
    v_add_u32 v17, 16384, v6
    ds_read_b128 a[160:163], v17
    v_xor_b32 v18, 32, v17
    ds_read_b128 a[164:167], v18
    v_xor_b32 v19, 64, v17
    ds_read_b128 a[168:171], v19
    v_xor_b32 v18, 96, v17
    ds_read_b128 a[172:175], v18
    v_xor_b32 v19, 128, v17
    ds_read_b128 a[176:179], v19
    v_xor_b32 v18, 160, v17
    ds_read_b128 a[180:183], v18
    v_xor_b32 v19, 192, v17
    ds_read_b128 a[184:187], v19
    v_xor_b32 v18, 224, v17
    ds_read_b128 a[188:191], v18
L_kr_15:
    s_waitcnt vmcnt(16)
    v_alignbit_b32 v18, v65, v65, 5
    v_alignbit_b32 v19, v66, v66, 11
    v_add3_u32 v18, v64, v18, v19
    v_alignbit_b32 v19, v67, v67, 19
    v_add3_u32 v18, v18, v19, v14
    v_xor_b32 v17, v18, v72
    v_alignbit_b32 v18, v69, v69, 5
    v_alignbit_b32 v19, v70, v70, 11
    v_add3_u32 v18, v68, v18, v19
    v_alignbit_b32 v19, v71, v71, 19
    v_add3_u32 v18, v18, v19, v14
    v_bitop3_b32 v17, v17, v18, v73 bitop3:0xf6
    v_cmp_ne_u32 vcc, 0, v17
    s_nop 1
    s_cbranch_vccz L_q_ok_16
    s_mov_b32 s59, 0
L_q_re_17:
    s_add_u32 s53, s62, 65536
    s_andn2_b32 s52, s49, 7
    s_and_b32 s54, s29, 1
    s_lshl_b32 s54, s54, 2
    s_add_u32 s52, s52, s54
    s_lshr_b32 s54, s3, 1
    s_add_u32 s52, s52, s54
    s_lshl_b32 s52, s52, 2
    s_and_b32 s54, s3, 1
    s_add_u32 s52, s52, s54
    s_lshl_b32 s52, s52, 8
    s_and_b32 s54, s30, 1
    s_lshl_b32 s54, s54, 6
    s_add_u32 s52, s52, s54
    s_add_u32 s52, s52, 1114112
    v_and_b32 v20, 47, v0
    v_lshlrev_b32 v20, 2, v20
    v_bfe_u32 v21, v0, 4, 1
    v_lshl_add_u32 v20, v21, 11, v20
    buffer_load_dwordx4 v[64:67], v8, s[12:15], s53 offen offset:0 sc1
    buffer_load_dwordx4 v[68:71], v8, s[12:15], s53 offen offset:1024 sc1
    buffer_load_dword v72, v20, s[12:15], s52 offen offset:0 sc1
    buffer_load_dword v73, v20, s[12:15], s52 offen offset:512 sc1
    s_waitcnt vmcnt(0)
    s_add_u32 s59, s59, 1
    s_cmp_gt_u32 s59, 65536
    s_cbranch_scc1 L_q_ok_16
    v_alignbit_b32 v18, v65, v65, 5
    v_alignbit_b32 v19, v66, v66, 11
    v_add3_u32 v18, v64, v18, v19
    v_alignbit_b32 v19, v67, v67, 19
    v_add3_u32 v18, v18, v19, v14
    v_xor_b32 v17, v18, v72
    v_alignbit_b32 v18, v69, v69, 5
    v_alignbit_b32 v19, v70, v70, 11
    v_add3_u32 v18, v68, v18, v19
    v_alignbit_b32 v19, v71, v71, 19
    v_add3_u32 v18, v18, v19, v14
    v_bitop3_b32 v17, v17, v18, v73 bitop3:0xf6
    v_cmp_ne_u32 vcc, 0, v17
    s_nop 1
    s_cbranch_vccnz L_q_re_17
L_q_ok_16:
    s_lshl_b32 s52, s3, 11
    s_add_u32 s52, s52, 147456
    v_add_u32 v17, s52, v8
    ds_write_b128 v17, v[64:67]
    ds_write_b128 v17, v[68:71] offset:1024
    s_waitcnt lgkmcnt(0)
    s_waitcnt vmcnt(12)
    s_barrier
    s_add_u32 m0, s50, 98304
    s_mov_b32 s51, 245760
    buffer_load_dwordx4 v1, s[4:7], s51 offen offset:0 nt lds
    buffer_load_dwordx4 v2, s[4:7], s51 offen offset:1024 nt lds
    buffer_load_dwordx4 v3, s[4:7], s51 offen offset:2048 nt lds
    buffer_load_dwordx4 v4, s[4:7], s51 offen offset:3072 nt lds
    s_cmp_lt_u32 s3, 2
    s_cbranch_scc1 L_kr_18
    v_add_u32 v17, 32768, v6
    ds_read_b128 a[160:163], v17
    v_xor_b32 v18, 32, v17
    ds_read_b128 a[164:167], v18
    v_xor_b32 v19, 64, v17
    ds_read_b128 a[168:171], v19
    v_xor_b32 v18, 96, v17
    ds_read_b128 a[172:175], v18
    v_xor_b32 v19, 128, v17
    ds_read_b128 a[176:179], v19
    v_xor_b32 v18, 160, v17
    ds_read_b128 a[180:183], v18
    v_xor_b32 v19, 192, v17
    ds_read_b128 a[184:187], v19
    v_xor_b32 v18, 224, v17
    ds_read_b128 a[188:191], v18
L_kr_18:
    ds_read_b128 v[96:99], v28 offset:0
    ds_read_b128 v[100:103], v28 offset:1024
    ds_read_b128 v[104:107], v28 offset:2048
    ds_read_b128 v[108:111], v28 offset:3072
    ds_read_b128 v[112:115], v28 offset:4096
    ds_read_b128 v[116:119], v28 offset:5120
    ds_read_b128 v[120:123], v28 offset:6144
    ds_read_b128 v[124:127], v28 offset:7168
    s_waitcnt lgkmcnt(0)
    v_mfma_f32_32x32x16_bf16 v[128:143], a[0:3], v[96:99], 0
    v_mfma_f32_32x32x16_bf16 v[128:143], a[4:7], v[100:103], v[128:143]
    v_mfma_f32_32x32x16_bf16 v[128:143], a[8:11], v[104:107], v[128:143]
    v_mfma_f32_32x32x16_bf16 v[128:143], a[12:15], v[108:111], v[128:143]
    v_mfma_f32_32x32x16_bf16 v[128:143], a[16:19], v[112:115], v[128:143]
    v_mfma_f32_32x32x16_bf16 v[128:143], a[20:23], v[116:119], v[128:143]
    v_mfma_f32_32x32x16_bf16 v[128:143], a[24:27], v[120:123], v[128:143]
    v_mfma_f32_32x32x16_bf16 v[128:143], a[28:31], v[124:127], v[128:143]
    v_mfma_f32_32x32x16_bf16 v[144:159], a[32:35], v[96:99], 0
    v_mfma_f32_32x32x16_bf16 v[144:159], a[36:39], v[100:103], v[144:159]
    v_mfma_f32_32x32x16_bf16 v[144:159], a[40:43], v[104:107], v[144:159]
    v_mfma_f32_32x32x16_bf16 v[144:159], a[44:47], v[108:111], v[144:159]
    v_mfma_f32_32x32x16_bf16 v[144:159], a[48:51], v[112:115], v[144:159]
    v_mfma_f32_32x32x16_bf16 v[144:159], a[52:55], v[116:119], v[144:159]
    v_mfma_f32_32x32x16_bf16 v[144:159], a[56:59], v[120:123], v[144:159]
    v_mfma_f32_32x32x16_bf16 v[144:159], a[60:63], v[124:127], v[144:159]
    s_nop 3
    v_max3_f32 v9, v9, v128, v129
    v_max3_f32 v9, v9, v130, v131
    v_max3_f32 v9, v9, v132, v133
    v_max3_f32 v9, v9, v134, v135
    v_max3_f32 v9, v9, v136, v137
    v_max3_f32 v9, v9, v138, v139
    v_max3_f32 v9, v9, v140, v141
    v_max3_f32 v9, v9, v142, v143
    s_waitcnt lgkmcnt(0)
    s_waitcnt vmcnt(12)
    s_barrier
    s_add_u32 m0, s50, 114688
    s_mov_b32 s51, 0
    buffer_load_dwordx4 v5, s[8:11], s51 offen offset:0 nt lds
    buffer_load_dwordx4 v5, s[8:11], s51 offen offset:1024 nt lds
    buffer_load_dwordx4 v5, s[8:11], s51 offen offset:2048 nt lds
    buffer_load_dwordx4 v5, s[8:11], s51 offen offset:3072 nt lds
    s_cmp_ge_u32 s3, 2
    s_cbranch_scc1 L_kr_19
    v_add_u32 v17, 49152, v6
    ds_read_b128 a[192:195], v17
    v_xor_b32 v18, 32, v17
    ds_read_b128 a[196:199], v18
    v_xor_b32 v19, 64, v17
    ds_read_b128 a[200:203], v19
    v_xor_b32 v18, 96, v17
    ds_read_b128 a[204:207], v18
    v_xor_b32 v19, 128, v17
    ds_read_b128 a[208:211], v19
    v_xor_b32 v18, 160, v17
    ds_read_b128 a[212:215], v18
    v_xor_b32 v19, 192, v17
    ds_read_b128 a[216:219], v19
    v_xor_b32 v18, 224, v17
    ds_read_b128 a[220:223], v18
L_kr_19:
    v_mfma_f32_32x32x16_bf16 v[160:175], a[64:67], v[96:99], 0
    v_mfma_f32_32x32x16_bf16 v[160:175], a[68:71], v[100:103], v[160:175]
    v_mfma_f32_32x32x16_bf16 v[160:175], a[72:75], v[104:107], v[160:175]
    v_mfma_f32_32x32x16_bf16 v[160:175], a[76:79], v[108:111], v[160:175]
    v_mfma_f32_32x32x16_bf16 v[160:175], a[80:83], v[112:115], v[160:175]
    v_mfma_f32_32x32x16_bf16 v[160:175], a[84:87], v[116:119], v[160:175]
    v_mfma_f32_32x32x16_bf16 v[160:175], a[88:91], v[120:123], v[160:175]
    v_mfma_f32_32x32x16_bf16 v[160:175], a[92:95], v[124:127], v[160:175]
    s_nop 3
    v_max3_f32 v9, v9, v144, v145
    v_max3_f32 v9, v9, v146, v147
    v_max3_f32 v9, v9, v148, v149
    v_max3_f32 v9, v9, v150, v151
    v_max3_f32 v9, v9, v152, v153
    v_max3_f32 v9, v9, v154, v155
    v_max3_f32 v9, v9, v156, v157
    v_max3_f32 v9, v9, v158, v159
    v_mfma_f32_32x32x16_bf16 v[176:191], a[96:99], v[96:99], 0
    v_mfma_f32_32x32x16_bf16 v[176:191], a[100:103], v[100:103], v[176:191]
    v_mfma_f32_32x32x16_bf16 v[176:191], a[104:107], v[104:107], v[176:191]
    v_mfma_f32_32x32x16_bf16 v[176:191], a[108:111], v[108:111], v[176:191]
    v_mfma_f32_32x32x16_bf16 v[176:191], a[112:115], v[112:115], v[176:191]
    v_mfma_f32_32x32x16_bf16 v[176:191], a[116:119], v[116:119], v[176:191]
    v_mfma_f32_32x32x16_bf16 v[176:191], a[120:123], v[120:123], v[176:191]
    v_mfma_f32_32x32x16_bf16 v[176:191], a[124:127], v[124:127], v[176:191]
    s_nop 3
    v_max3_f32 v9, v9, v160, v161
    v_max3_f32 v9, v9, v162, v163
    v_max3_f32 v9, v9, v164, v165
    v_max3_f32 v9, v9, v166, v167
    v_max3_f32 v9, v9, v168, v169
    v_max3_f32 v9, v9, v170, v171
    v_max3_f32 v9, v9, v172, v173
    v_max3_f32 v9, v9, v174, v175
    s_waitcnt lgkmcnt(0)
    s_waitcnt vmcnt(12)
    s_barrier
    s_add_u32 m0, s50, 131072
    s_add_u32 s51, s27, 0
    buffer_load_dwordx4 v37, s[16:19], s51 offen  lds
    s_add_u32 m0, s50, 132096
    s_add_u32 s51, s27, 9216
    buffer_load_dwordx4 v37, s[16:19], s51 offen  lds
    s_add_u32 m0, s50, 133120
    s_add_u32 s51, s27, 18432
    buffer_load_dwordx4 v37, s[16:19], s51 offen  lds
    s_add_u32 m0, s50, 134144
    s_add_u32 s51, s27, 27648
    buffer_load_dwordx4 v37, s[16:19], s51 offen  lds
    s_cmp_lt_u32 s3, 2
    s_cbranch_scc1 L_kr_20
    v_add_u32 v17, 65536, v6
    ds_read_b128 a[192:195], v17
    v_xor_b32 v18, 32, v17
    ds_read_b128 a[196:199], v18
    v_xor_b32 v19, 64, v17
    ds_read_b128 a[200:203], v19
    v_xor_b32 v18, 96, v17
    ds_read_b128 a[204:207], v18
    v_xor_b32 v19, 128, v17
    ds_read_b128 a[208:211], v19
    v_xor_b32 v18, 160, v17
    ds_read_b128 a[212:215], v18
    v_xor_b32 v19, 192, v17
    ds_read_b128 a[216:219], v19
    v_xor_b32 v18, 224, v17
    ds_read_b128 a[220:223], v18
L_kr_20:
    v_mfma_f32_32x32x16_bf16 v[192:207], a[128:131], v[96:99], 0
    v_mfma_f32_32x32x16_bf16 v[192:207], a[132:135], v[100:103], v[192:207]
    v_mfma_f32_32x32x16_bf16 v[192:207], a[136:139], v[104:107], v[192:207]
    v_mfma_f32_32x32x16_bf16 v[192:207], a[140:143], v[108:111], v[192:207]
    v_mfma_f32_32x32x16_bf16 v[192:207], a[144:147], v[112:115], v[192:207]
    v_mfma_f32_32x32x16_bf16 v[192:207], a[148:151], v[116:119], v[192:207]
    v_mfma_f32_32x32x16_bf16 v[192:207], a[152:155], v[120:123], v[192:207]
    v_mfma_f32_32x32x16_bf16 v[192:207], a[156:159], v[124:127], v[192:207]
    s_nop 3
    v_max3_f32 v9, v9, v176, v177
    v_max3_f32 v9, v9, v178, v179
    v_max3_f32 v9, v9, v180, v181
    v_max3_f32 v9, v9, v182, v183
    v_max3_f32 v9, v9, v184, v185
    v_max3_f32 v9, v9, v186, v187
    v_max3_f32 v9, v9, v188, v189
    v_max3_f32 v9, v9, v190, v191
    v_mfma_f32_32x32x16_bf16 v[208:223], a[160:163], v[96:99], 0
    v_mfma_f32_32x32x16_bf16 v[208:223], a[164:167], v[100:103], v[208:223]
    v_mfma_f32_32x32x16_bf16 v[208:223], a[168:171], v[104:107], v[208:223]
    v_mfma_f32_32x32x16_bf16 v[208:223], a[172:175], v[108:111], v[208:223]
    v_mfma_f32_32x32x16_bf16 v[208:223], a[176:179], v[112:115], v[208:223]
    v_mfma_f32_32x32x16_bf16 v[208:223], a[180:183], v[116:119], v[208:223]
    v_mfma_f32_32x32x16_bf16 v[208:223], a[184:187], v[120:123], v[208:223]
    v_mfma_f32_32x32x16_bf16 v[208:223], a[188:191], v[124:127], v[208:223]
    s_nop 3
    v_max3_f32 v9, v9, v192, v193
    v_max3_f32 v9, v9, v194, v195
    v_max3_f32 v9, v9, v196, v197
    v_max3_f32 v9, v9, v198, v199
    v_max3_f32 v9, v9, v200, v201
    v_max3_f32 v9, v9, v202, v203
    v_max3_f32 v9, v9, v204, v205
    v_max3_f32 v9, v9, v206, v207
    s_waitcnt lgkmcnt(0)
    s_waitcnt vmcnt(12)
    s_barrier
    s_add_u32 m0, s50, 0
    s_mov_b32 s51, 16384
    buffer_load_dwordx4 v5, s[8:11], s51 offen offset:0 nt lds
    buffer_load_dwordx4 v5, s[8:11], s51 offen offset:1024 nt lds
    buffer_load_dwordx4 v5, s[8:11], s51 offen offset:2048 nt lds
    buffer_load_dwordx4 v5, s[8:11], s51 offen offset:3072 nt lds
    s_cmp_ge_u32 s3, 2
    s_cbranch_scc1 L_kr_21
    v_add_u32 v17, 81920, v6
    ds_read_b128 a[224:227], v17
    v_xor_b32 v18, 32, v17
    ds_read_b128 a[228:231], v18
    v_xor_b32 v19, 64, v17
    ds_read_b128 a[232:235], v19
    v_xor_b32 v18, 96, v17
    ds_read_b128 a[236:239], v18
    v_xor_b32 v19, 128, v17
    ds_read_b128 a[240:243], v19
    v_xor_b32 v18, 160, v17
    ds_read_b128 a[244:247], v18
    v_xor_b32 v19, 192, v17
    ds_read_b128 a[248:251], v19
    v_xor_b32 v18, 224, v17
    ds_read_b128 a[252:255], v18
L_kr_21:
    v_mfma_f32_32x32x16_bf16 v[224:239], a[192:195], v[96:99], 0
    v_mfma_f32_32x32x16_bf16 v[224:239], a[196:199], v[100:103], v[224:239]
    v_mfma_f32_32x32x16_bf16 v[224:239], a[200:203], v[104:107], v[224:239]
    v_mfma_f32_32x32x16_bf16 v[224:239], a[204:207], v[108:111], v[224:239]
    v_mfma_f32_32x32x16_bf16 v[224:239], a[208:211], v[112:115], v[224:239]
    v_mfma_f32_32x32x16_bf16 v[224:239], a[212:215], v[116:119], v[224:239]
    v_mfma_f32_32x32x16_bf16 v[224:239], a[216:219], v[120:123], v[224:239]
    v_mfma_f32_32x32x16_bf16 v[224:239], a[220:223], v[124:127], v[224:239]
    s_nop 3
    v_max3_f32 v9, v9, v208, v209
    v_max3_f32 v9, v9, v210, v211
    v_max3_f32 v9, v9, v212, v213
    v_max3_f32 v9, v9, v214, v215
    v_max3_f32 v9, v9, v216, v217
    v_max3_f32 v9, v9, v218, v219
    v_max3_f32 v9, v9, v220, v221
    v_max3_f32 v9, v9, v222, v223
    s_waitcnt lgkmcnt(0)
    s_waitcnt vmcnt(12)
    s_barrier
    s_add_u32 m0, s50, 16384
    s_mov_b32 s51, 32768
    buffer_load_dwordx4 v5, s[8:11], s51 offen offset:0 nt lds
    buffer_load_dwordx4 v5, s[8:11], s51 offen offset:1024 nt lds
    buffer_load_dwordx4 v5, s[8:11], s51 offen offset:2048 nt lds
    buffer_load_dwordx4 v5, s[8:11], s51 offen offset:3072 nt lds
    s_cmp_lt_u32 s3, 2
    s_cbranch_scc1 L_kr_22
    v_add_u32 v17, 98304, v6
    ds_read_b128 a[224:227], v17
    v_xor_b32 v18, 32, v17
    ds_read_b128 a[228:231], v18
    v_xor_b32 v19, 64, v17
    ds_read_b128 a[232:235], v19
    v_xor_b32 v18, 96, v17
    ds_read_b128 a[236:239], v18
    v_xor_b32 v19, 128, v17
    ds_read_b128 a[240:243], v19
    v_xor_b32 v18, 160, v17
    ds_read_b128 a[244:247], v18
    v_xor_b32 v19, 192, v17
    ds_read_b128 a[248:251], v19
    v_xor_b32 v18, 224, v17
    ds_read_b128 a[252:255], v18
L_kr_22:
    s_waitcnt lgkmcnt(0)
    v_mfma_f32_32x32x16_bf16 v[240:255], a[224:227], v[96:99], 0
    v_mfma_f32_32x32x16_bf16 v[240:255], a[228:231], v[100:103], v[240:255]
    v_mfma_f32_32x32x16_bf16 v[240:255], a[232:235], v[104:107], v[240:255]
    v_mfma_f32_32x32x16_bf16 v[240:255], a[236:239], v[108:111], v[240:255]
    v_mfma_f32_32x32x16_bf16 v[240:255], a[240:243], v[112:115], v[240:255]
    v_mfma_f32_32x32x16_bf16 v[240:255], a[244:247], v[116:119], v[240:255]
    v_mfma_f32_32x32x16_bf16 v[240:255], a[248:251], v[120:123], v[240:255]
    v_mfma_f32_32x32x16_bf16 v[240:255], a[252:255], v[124:127], v[240:255]
    s_nop 3
    v_max3_f32 v9, v9, v224, v225
    v_max3_f32 v9, v9, v226, v227
    v_max3_f32 v9, v9, v228, v229
    v_max3_f32 v9, v9, v230, v231
    v_max3_f32 v9, v9, v232, v233
    v_max3_f32 v9, v9, v234, v235
    v_max3_f32 v9, v9, v236, v237
    v_max3_f32 v9, v9, v238, v239
    s_nop 11
    v_max3_f32 v9, v9, v240, v241
    v_max3_f32 v9, v9, v242, v243
    v_max3_f32 v9, v9, v244, v245
    v_max3_f32 v9, v9, v246, v247
    v_max3_f32 v9, v9, v248, v249
    v_max3_f32 v9, v9, v250, v251
    v_max3_f32 v9, v9, v252, v253
    v_max3_f32 v9, v9, v254, v255
    v_mov_b32 v18, v9
    s_nop 1
    v_permlane32_swap_b32 v9, v18
    v_max_f32 v9, v9, v18
    ds_write_b32 v29, v9
    s_waitcnt lgkmcnt(0)
    s_barrier
    s_add_u32 m0, s50, 32768
    s_mov_b32 s51, 0
    buffer_load_dwordx4 v37, s[16:19], s51 offen  lds
    s_add_u32 m0, s50, 33792
    s_mov_b32 s51, 9216
    buffer_load_dwordx4 v37, s[16:19], s51 offen  lds
    s_add_u32 m0, s50, 34816
    s_mov_b32 s51, 18432
    buffer_load_dwordx4 v37, s[16:19], s51 offen  lds
    s_add_u32 m0, s50, 35840
    s_mov_b32 s51, 27648
    buffer_load_dwordx4 v37, s[16:19], s51 offen  lds
    s_add_u32 m0, s50, 49152
    s_mov_b32 s51, 49152
    buffer_load_dwordx4 v5, s[8:11], s51 offen offset:0 nt lds
    buffer_load_dwordx4 v5, s[8:11], s51 offen offset:1024 nt lds
    buffer_load_dwordx4 v5, s[8:11], s51 offen offset:2048 nt lds
    buffer_load_dwordx4 v5, s[8:11], s51 offen offset:3072 nt lds
    ds_read2_b32 v[18:19], v30 offset0:0 offset1:32
    ds_read2_b32 v[20:21], v30 offset0:64 offset1:96
    s_waitcnt lgkmcnt(0)
    v_max3_f32 v9, v18, v19, v20
    v_max_f32 v9, v9, v21
    v_mul_f32 v13, s56, v9
    v_fma_f32 v128, v128, s56, -v13
    v_fma_f32 v129, v129, s56, -v13
    v_fma_f32 v130, v130, s56, -v13
    v_fma_f32 v131, v131, s56, -v13
    v_fma_f32 v132, v132, s56, -v13
    v_fma_f32 v133, v133, s56, -v13
    v_fma_f32 v134, v134, s56, -v13
    v_fma_f32 v135, v135, s56, -v13
    v_fma_f32 v136, v136, s56, -v13
    v_fma_f32 v137, v137, s56, -v13
    v_fma_f32 v138, v138, s56, -v13
    v_fma_f32 v139, v139, s56, -v13
    v_fma_f32 v140, v140, s56, -v13
    v_fma_f32 v141, v141, s56, -v13
    v_fma_f32 v142, v142, s56, -v13
    v_fma_f32 v143, v143, s56, -v13
    v_exp_f32 v128, v128
    v_exp_f32 v129, v129
    v_exp_f32 v130, v130
    v_exp_f32 v131, v131
    v_exp_f32 v132, v132
    v_exp_f32 v133, v133
    v_exp_f32 v134, v134
    v_exp_f32 v135, v135
    v_exp_f32 v136, v136
    v_exp_f32 v137, v137
    v_exp_f32 v138, v138
    v_exp_f32 v139, v139
    v_exp_f32 v140, v140
    v_exp_f32 v141, v141
    v_exp_f32 v142, v142
    v_exp_f32 v143, v143
    v_add_f32 v11, v11, v128
    v_add_f32 v12, v12, v129
    v_cvt_pk_bf16_f32 v128, v128, v129
    v_add_f32 v11, v11, v130
    v_add_f32 v12, v12, v131
    v_cvt_pk_bf16_f32 v129, v130, v131
    v_add_f32 v11, v11, v132
    v_add_f32 v12, v12, v133
    v_cvt_pk_bf16_f32 v130, v132, v133
    v_add_f32 v11, v11, v134
    v_add_f32 v12, v12, v135
    v_cvt_pk_bf16_f32 v131, v134, v135
    v_add_f32 v11, v11, v136
    v_add_f32 v12, v12, v137
    v_cvt_pk_bf16_f32 v132, v136, v137
    v_add_f32 v11, v11, v138
    v_add_f32 v12, v12, v139
    v_cvt_pk_bf16_f32 v133, v138, v139
    v_add_f32 v11, v11, v140
    v_add_f32 v12, v12, v141
    v_cvt_pk_bf16_f32 v134, v140, v141
    v_add_f32 v11, v11, v142
    v_add_f32 v12, v12, v143
    v_cvt_pk_bf16_f32 v135, v142, v143
    s_cmp_ge_u32 s3, 2
    s_cbranch_scc1 L_pw_23
    ds_write_b128 v27, v[128:131] offset:0
    ds_write_b128 v27, v[132:135] offset:1024
L_pw_23:
    s_waitcnt lgkmcnt(0)
    s_waitcnt vmcnt(20)
    s_barrier
    v_add_u32 v17, 114688, v7
    ds_read_b128 v[52:55], v28 offset:0
    ds_read_b64_tr_b16 v[48:49], v17 offset:0
    ds_read_b64_tr_b16 v[50:51], v17 offset:2048
    ds_read_b128 v[60:63], v28 offset:1024
    ds_read_b64_tr_b16 v[56:57], v17 offset:4096
    ds_read_b64_tr_b16 v[58:59], v17 offset:6144
    ds_read_b128 v[68:71], v28 offset:2048
    ds_read_b64_tr_b16 v[64:65], v17 offset:8192
    ds_read_b64_tr_b16 v[66:67], v17 offset:10240
    ds_read_b128 v[76:79], v28 offset:3072
    ds_read_b64_tr_b16 v[72:73], v17 offset:12288
    ds_read_b64_tr_b16 v[74:75], v17 offset:14336
    s_waitcnt lgkmcnt(9)
    v_mfma_f32_32x32x16_bf16 v[80:95], v[48:51], v[52:55], 0
    s_waitcnt lgkmcnt(6)
    v_mfma_f32_32x32x16_bf16 v[80:95], v[56:59], v[60:63], v[80:95]
    s_waitcnt lgkmcnt(3)
    v_mfma_f32_32x32x16_bf16 v[80:95], v[64:67], v[68:71], v[80:95]
    s_waitcnt lgkmcnt(0)
    v_mfma_f32_32x32x16_bf16 v[80:95], v[72:75], v[76:79], v[80:95]
    v_fma_f32 v144, v144, s56, -v13
    v_fma_f32 v145, v145, s56, -v13
    v_fma_f32 v146, v146, s56, -v13
    v_fma_f32 v147, v147, s56, -v13
    v_fma_f32 v148, v148, s56, -v13
    v_fma_f32 v149, v149, s56, -v13
    v_fma_f32 v150, v150, s56, -v13
    v_fma_f32 v151, v151, s56, -v13
    v_fma_f32 v152, v152, s56, -v13
    v_fma_f32 v153, v153, s56, -v13
    v_fma_f32 v154, v154, s56, -v13
    v_fma_f32 v155, v155, s56, -v13
    v_fma_f32 v156, v156, s56, -v13
    v_fma_f32 v157, v157, s56, -v13
    v_fma_f32 v158, v158, s56, -v13
    v_fma_f32 v159, v159, s56, -v13
    v_exp_f32 v144, v144
    v_exp_f32 v145, v145
    v_exp_f32 v146, v146
    v_exp_f32 v147, v147
    v_exp_f32 v148, v148
    v_exp_f32 v149, v149
    v_exp_f32 v150, v150
    v_exp_f32 v151, v151
    v_exp_f32 v152, v152
    v_exp_f32 v153, v153
    v_exp_f32 v154, v154
    v_exp_f32 v155, v155
    v_exp_f32 v156, v156
    v_exp_f32 v157, v157
    v_exp_f32 v158, v158
    v_exp_f32 v159, v159
    v_add_f32 v11, v11, v144
    v_add_f32 v12, v12, v145
    v_cvt_pk_bf16_f32 v144, v144, v145
    v_add_f32 v11, v11, v146
    v_add_f32 v12, v12, v147
    v_cvt_pk_bf16_f32 v145, v146, v147
    v_add_f32 v11, v11, v148
    v_add_f32 v12, v12, v149
    v_cvt_pk_bf16_f32 v146, v148, v149
    v_add_f32 v11, v11, v150
    v_add_f32 v12, v12, v151
    v_cvt_pk_bf16_f32 v147, v150, v151
    v_add_f32 v11, v11, v152
    v_add_f32 v12, v12, v153
    v_cvt_pk_bf16_f32 v148, v152, v153
    v_add_f32 v11, v11, v154
    v_add_f32 v12, v12, v155
    v_cvt_pk_bf16_f32 v149, v154, v155
    v_add_f32 v11, v11, v156
    v_add_f32 v12, v12, v157
    v_cvt_pk_bf16_f32 v150, v156, v157
    v_add_f32 v11, v11, v158
    v_add_f32 v12, v12, v159
    v_cvt_pk_bf16_f32 v151, v158, v159
    v_fma_f32 v160, v160, s56, -v13
    v_fma_f32 v161, v161, s56, -v13
    v_fma_f32 v162, v162, s56, -v13
    v_fma_f32 v163, v163, s56, -v13
    v_fma_f32 v164, v164, s56, -v13
    v_fma_f32 v165, v165, s56, -v13
    v_fma_f32 v166, v166, s56, -v13
    v_fma_f32 v167, v167, s56, -v13
    v_fma_f32 v168, v168, s56, -v13
    v_fma_f32 v169, v169, s56, -v13
    v_fma_f32 v170, v170, s56, -v13
    v_fma_f32 v171, v171, s56, -v13
    v_fma_f32 v172, v172, s56, -v13
    v_fma_f32 v173, v173, s56, -v13
    v_fma_f32 v174, v174, s56, -v13
    v_fma_f32 v175, v175, s56, -v13
    v_exp_f32 v160, v160
    v_exp_f32 v161, v161
    v_exp_f32 v162, v162
    v_exp_f32 v163, v163
    v_exp_f32 v164, v164
    v_exp_f32 v165, v165
    v_exp_f32 v166, v166
    v_exp_f32 v167, v167
    v_exp_f32 v168, v168
    v_exp_f32 v169, v169
    v_exp_f32 v170, v170
    v_exp_f32 v171, v171
    v_exp_f32 v172, v172
    v_exp_f32 v173, v173
    v_exp_f32 v174, v174
    v_exp_f32 v175, v175
    v_add_f32 v11, v11, v160
    v_add_f32 v12, v12, v161
    v_cvt_pk_bf16_f32 v160, v160, v161
    v_add_f32 v11, v11, v162
    v_add_f32 v12, v12, v163
    v_cvt_pk_bf16_f32 v161, v162, v163
    v_add_f32 v11, v11, v164
    v_add_f32 v12, v12, v165
    v_cvt_pk_bf16_f32 v162, v164, v165
    v_add_f32 v11, v11, v166
    v_add_f32 v12, v12, v167
    v_cvt_pk_bf16_f32 v163, v166, v167
    v_add_f32 v11, v11, v168
    v_add_f32 v12, v12, v169
    v_cvt_pk_bf16_f32 v164, v168, v169
    v_add_f32 v11, v11, v170
    v_add_f32 v12, v12, v171
    v_cvt_pk_bf16_f32 v165, v170, v171
    v_add_f32 v11, v11, v172
    v_add_f32 v12, v12, v173
    v_cvt_pk_bf16_f32 v166, v172, v173
    v_add_f32 v11, v11, v174
    v_add_f32 v12, v12, v175
    v_cvt_pk_bf16_f32 v167, v174, v175
    s_cmp_lt_u32 s3, 2
    s_cbranch_scc1 L_pw_24
    ds_write_b128 v27, v[128:131] offset:4096
    ds_write_b128 v27, v[132:135] offset:5120
L_pw_24:
    s_waitcnt lgkmcnt(0)
    s_waitcnt vmcnt(12)
    s_barrier
    s_add_u32 m0, s50, 65536
    s_mov_b32 s51, 65536
    buffer_load_dwordx4 v5, s[8:11], s51 offen offset:0 nt lds
    buffer_load_dwordx4 v5, s[8:11], s51 offen offset:1024 nt lds
    buffer_load_dwordx4 v5, s[8:11], s51 offen offset:2048 nt lds
    buffer_load_dwordx4 v5, s[8:11], s51 offen offset:3072 nt lds
    s_add_u32 m0, s50, 81920
    s_mov_b32 s51, 128
    buffer_load_dwordx4 v37, s[16:19], s51 offen  lds
    s_add_u32 m0, s50, 82944
    s_mov_b32 s51, 9344
    buffer_load_dwordx4 v37, s[16:19], s51 offen  lds
    s_add_u32 m0, s50, 83968
    s_mov_b32 s51, 18560
    buffer_load_dwordx4 v37, s[16:19], s51 offen  lds
    s_add_u32 m0, s50, 84992
    s_mov_b32 s51, 27776
    buffer_load_dwordx4 v37, s[16:19], s51 offen  lds
    v_add_u32 v17, 0, v7
    ds_read_b128 v[52:55], v28 offset:4096
    ds_read_b64_tr_b16 v[48:49], v17 offset:0
    ds_read_b64_tr_b16 v[50:51], v17 offset:2048
    ds_read_b128 v[60:63], v28 offset:5120
    ds_read_b64_tr_b16 v[56:57], v17 offset:4096
    ds_read_b64_tr_b16 v[58:59], v17 offset:6144
    ds_read_b128 v[68:71], v28 offset:6144
    ds_read_b64_tr_b16 v[64:65], v17 offset:8192
    ds_read_b64_tr_b16 v[66:67], v17 offset:10240
    ds_read_b128 v[76:79], v28 offset:7168
    ds_read_b64_tr_b16 v[72:73], v17 offset:12288
    ds_read_b64_tr_b16 v[74:75], v17 offset:14336
    s_waitcnt lgkmcnt(9)
    v_mfma_f32_32x32x16_bf16 v[80:95], v[48:51], v[52:55], v[80:95]
    s_waitcnt lgkmcnt(6)
    v_mfma_f32_32x32x16_bf16 v[80:95], v[56:59], v[60:63], v[80:95]
    s_waitcnt lgkmcnt(3)
    v_mfma_f32_32x32x16_bf16 v[80:95], v[64:67], v[68:71], v[80:95]
    s_waitcnt lgkmcnt(0)
    v_mfma_f32_32x32x16_bf16 v[80:95], v[72:75], v[76:79], v[80:95]
    v_add_u32 v17, 131072, v39
    v_xor_b32 v18, 8192, v17
    ds_read_b64_tr_b16 a[128:129], v17 offset:0
    ds_read_b64_tr_b16 a[130:131], v17 offset:1024
    ds_read_b64_tr_b16 a[132:133], v17 offset:4096
    ds_read_b64_tr_b16 a[134:135], v17 offset:5120
    ds_read_b64_tr_b16 a[136:137], v18 offset:0
    ds_read_b64_tr_b16 a[138:139], v18 offset:1024
    ds_read_b64_tr_b16 a[140:141], v18 offset:4096
    ds_read_b64_tr_b16 a[142:143], v18 offset:5120
    v_fma_f32 v176, v176, s56, -v13
    v_fma_f32 v177, v177, s56, -v13
    v_fma_f32 v178, v178, s56, -v13
    v_fma_f32 v179, v179, s56, -v13
    v_fma_f32 v180, v180, s56, -v13
    v_fma_f32 v181, v181, s56, -v13
    v_fma_f32 v182, v182, s56, -v13
    v_fma_f32 v183, v183, s56, -v13
    v_fma_f32 v184, v184, s56, -v13
    v_fma_f32 v185, v185, s56, -v13
    v_fma_f32 v186, v186, s56, -v13
    v_fma_f32 v187, v187, s56, -v13
    v_fma_f32 v188, v188, s56, -v13
    v_fma_f32 v189, v189, s56, -v13
    v_fma_f32 v190, v190, s56, -v13
    v_fma_f32 v191, v191, s56, -v13
    v_exp_f32 v176, v176
    v_exp_f32 v177, v177
    v_exp_f32 v178, v178
    v_exp_f32 v179, v179
    v_exp_f32 v180, v180
    v_exp_f32 v181, v181
    v_exp_f32 v182, v182
    v_exp_f32 v183, v183
    v_exp_f32 v184, v184
    v_exp_f32 v185, v185
    v_exp_f32 v186, v186
    v_exp_f32 v187, v187
    v_exp_f32 v188, v188
    v_exp_f32 v189, v189
    v_exp_f32 v190, v190
    v_exp_f32 v191, v191
    v_add_f32 v11, v11, v176
    v_add_f32 v12, v12, v177
    v_cvt_pk_bf16_f32 v176, v176, v177
    v_add_f32 v11, v11, v178
    v_add_f32 v12, v12, v179
    v_cvt_pk_bf16_f32 v177, v178, v179
    v_add_f32 v11, v11, v180
    v_add_f32 v12, v12, v181
    v_cvt_pk_bf16_f32 v178, v180, v181
    v_add_f32 v11, v11, v182
    v_add_f32 v12, v12, v183
    v_cvt_pk_bf16_f32 v179, v182, v183
    v_add_f32 v11, v11, v184
    v_add_f32 v12, v12, v185
    v_cvt_pk_bf16_f32 v180, v184, v185
    v_add_f32 v11, v11, v186
    v_add_f32 v12, v12, v187
    v_cvt_pk_bf16_f32 v181, v186, v187
    v_add_f32 v11, v11, v188
    v_add_f32 v12, v12, v189
    v_cvt_pk_bf16_f32 v182, v188, v189
    v_add_f32 v11, v11, v190
    v_add_f32 v12, v12, v191
    v_cvt_pk_bf16_f32 v183, v190, v191
    v_fma_f32 v192, v192, s56, -v13
    v_fma_f32 v193, v193, s56, -v13
    v_fma_f32 v194, v194, s56, -v13
    v_fma_f32 v195, v195, s56, -v13
    v_fma_f32 v196, v196, s56, -v13
    v_fma_f32 v197, v197, s56, -v13
    v_fma_f32 v198, v198, s56, -v13
    v_fma_f32 v199, v199, s56, -v13
    v_fma_f32 v200, v200, s56, -v13
    v_fma_f32 v201, v201, s56, -v13
    v_fma_f32 v202, v202, s56, -v13
    v_fma_f32 v203, v203, s56, -v13
    v_fma_f32 v204, v204, s56, -v13
    v_fma_f32 v205, v205, s56, -v13
    v_fma_f32 v206, v206, s56, -v13
    v_fma_f32 v207, v207, s56, -v13
    v_exp_f32 v192, v192
    v_exp_f32 v193, v193
    v_exp_f32 v194, v194
    v_exp_f32 v195, v195
    v_exp_f32 v196, v196
    v_exp_f32 v197, v197
    v_exp_f32 v198, v198
    v_exp_f32 v199, v199
    v_exp_f32 v200, v200
    v_exp_f32 v201, v201
    v_exp_f32 v202, v202
    v_exp_f32 v203, v203
    v_exp_f32 v204, v204
    v_exp_f32 v205, v205
    v_exp_f32 v206, v206
    v_exp_f32 v207, v207
    v_add_f32 v11, v11, v192
    v_add_f32 v12, v12, v193
    v_cvt_pk_bf16_f32 v192, v192, v193
    v_add_f32 v11, v11, v194
    v_add_f32 v12, v12, v195
    v_cvt_pk_bf16_f32 v193, v194, v195
    v_add_f32 v11, v11, v196
    v_add_f32 v12, v12, v197
    v_cvt_pk_bf16_f32 v194, v196, v197
    v_add_f32 v11, v11, v198
    v_add_f32 v12, v12, v199
    v_cvt_pk_bf16_f32 v195, v198, v199
    v_add_f32 v11, v11, v200
    v_add_f32 v12, v12, v201
    v_cvt_pk_bf16_f32 v196, v200, v201
    v_add_f32 v11, v11, v202
    v_add_f32 v12, v12, v203
    v_cvt_pk_bf16_f32 v197, v202, v203
    v_add_f32 v11, v11, v204
    v_add_f32 v12, v12, v205
    v_cvt_pk_bf16_f32 v198, v204, v205
    v_add_f32 v11, v11, v206
    v_add_f32 v12, v12, v207
    v_cvt_pk_bf16_f32 v199, v206, v207
    s_cmp_ge_u32 s3, 2
    s_cbranch_scc1 L_pw_25
    ds_write_b128 v27, v[144:147] offset:0
    ds_write_b128 v27, v[148:151] offset:1024
L_pw_25:
    s_waitcnt lgkmcnt(0)
    s_waitcnt vmcnt(16)
    s_barrier
    s_add_u32 m0, s50, 98304
    s_mov_b32 s51, 81920
    buffer_load_dwordx4 v5, s[8:11], s51 offen offset:0 nt lds
    buffer_load_dwordx4 v5, s[8:11], s51 offen offset:1024 nt lds
    buffer_load_dwordx4 v5, s[8:11], s51 offen offset:2048 nt lds
    buffer_load_dwordx4 v5, s[8:11], s51 offen offset:3072 nt lds
    v_add_u32 v17, 16384, v7
    ds_read_b128 v[52:55], v28 offset:0
    ds_read_b64_tr_b16 v[48:49], v17 offset:0
    ds_read_b64_tr_b16 v[50:51], v17 offset:2048
    ds_read_b128 v[60:63], v28 offset:1024
    ds_read_b64_tr_b16 v[56:57], v17 offset:4096
    ds_read_b64_tr_b16 v[58:59], v17 offset:6144
    ds_read_b128 v[68:71], v28 offset:2048
    ds_read_b64_tr_b16 v[64:65], v17 offset:8192
    ds_read_b64_tr_b16 v[66:67], v17 offset:10240
    ds_read_b128 v[76:79], v28 offset:3072
    ds_read_b64_tr_b16 v[72:73], v17 offset:12288
    ds_read_b64_tr_b16 v[74:75], v17 offset:14336
    s_waitcnt lgkmcnt(9)
    v_mfma_f32_32x32x16_bf16 v[80:95], v[48:51], v[52:55], v[80:95]
    s_waitcnt lgkmcnt(6)
    v_mfma_f32_32x32x16_bf16 v[80:95], v[56:59], v[60:63], v[80:95]
    s_waitcnt lgkmcnt(3)
    v_mfma_f32_32x32x16_bf16 v[80:95], v[64:67], v[68:71], v[80:95]
    s_waitcnt lgkmcnt(0)
    v_mfma_f32_32x32x16_bf16 v[80:95], v[72:75], v[76:79], v[80:95]
    v_fma_f32 v208, v208, s56, -v13
    v_fma_f32 v209, v209, s56, -v13
    v_fma_f32 v210, v210, s56, -v13
    v_fma_f32 v211, v211, s56, -v13
    v_fma_f32 v212, v212, s56, -v13
    v_fma_f32 v213, v213, s56, -v13
    v_fma_f32 v214, v214, s56, -v13
    v_fma_f32 v215, v215, s56, -v13
    v_fma_f32 v216, v216, s56, -v13
    v_fma_f32 v217, v217, s56, -v13
    v_fma_f32 v218, v218, s56, -v13
    v_fma_f32 v219, v219, s56, -v13
    v_fma_f32 v220, v220, s56, -v13
    v_fma_f32 v221, v221, s56, -v13
    v_fma_f32 v222, v222, s56, -v13
    v_fma_f32 v223, v223, s56, -v13
    v_exp_f32 v208, v208
    v_exp_f32 v209, v209
    v_exp_f32 v210, v210
    v_exp_f32 v211, v211
    v_exp_f32 v212, v212
    v_exp_f32 v213, v213
    v_exp_f32 v214, v214
    v_exp_f32 v215, v215
    v_exp_f32 v216, v216
    v_exp_f32 v217, v217
    v_exp_f32 v218, v218
    v_exp_f32 v219, v219
    v_exp_f32 v220, v220
    v_exp_f32 v221, v221
    v_exp_f32 v222, v222
    v_exp_f32 v223, v223
    v_add_f32 v11, v11, v208
    v_add_f32 v12, v12, v209
    v_cvt_pk_bf16_f32 v208, v208, v209
    v_add_f32 v11, v11, v210
    v_add_f32 v12, v12, v211
    v_cvt_pk_bf16_f32 v209, v210, v211
    v_add_f32 v11, v11, v212
    v_add_f32 v12, v12, v213
    v_cvt_pk_bf16_f32 v210, v212, v213
    v_add_f32 v11, v11, v214
    v_add_f32 v12, v12, v215
    v_cvt_pk_bf16_f32 v211, v214, v215
    v_add_f32 v11, v11, v216
    v_add_f32 v12, v12, v217
    v_cvt_pk_bf16_f32 v212, v216, v217
    v_add_f32 v11, v11, v218
    v_add_f32 v12, v12, v219
    v_cvt_pk_bf16_f32 v213, v218, v219
    v_add_f32 v11, v11, v220
    v_add_f32 v12, v12, v221
    v_cvt_pk_bf16_f32 v214, v220, v221
    v_add_f32 v11, v11, v222
    v_add_f32 v12, v12, v223
    v_cvt_pk_bf16_f32 v215, v222, v223
    v_fma_f32 v224, v224, s56, -v13
    v_fma_f32 v225, v225, s56, -v13
    v_fma_f32 v226, v226, s56, -v13
    v_fma_f32 v227, v227, s56, -v13
    v_fma_f32 v228, v228, s56, -v13
    v_fma_f32 v229, v229, s56, -v13
    v_fma_f32 v230, v230, s56, -v13
    v_fma_f32 v231, v231, s56, -v13
    v_fma_f32 v232, v232, s56, -v13
    v_fma_f32 v233, v233, s56, -v13
    v_fma_f32 v234, v234, s56, -v13
    v_fma_f32 v235, v235, s56, -v13
    v_fma_f32 v236, v236, s56, -v13
    v_fma_f32 v237, v237, s56, -v13
    v_fma_f32 v238, v238, s56, -v13
    v_fma_f32 v239, v239, s56, -v13
    v_exp_f32 v224, v224
    v_exp_f32 v225, v225
    v_exp_f32 v226, v226
    v_exp_f32 v227, v227
    v_exp_f32 v228, v228
    v_exp_f32 v229, v229
    v_exp_f32 v230, v230
    v_exp_f32 v231, v231
    v_exp_f32 v232, v232
    v_exp_f32 v233, v233
    v_exp_f32 v234, v234
    v_exp_f32 v235, v235
    v_exp_f32 v236, v236
    v_exp_f32 v237, v237
    v_exp_f32 v238, v238
    v_exp_f32 v239, v239
    v_add_f32 v11, v11, v224
    v_add_f32 v12, v12, v225
    v_cvt_pk_bf16_f32 v224, v224, v225
    v_add_f32 v11, v11, v226
    v_add_f32 v12, v12, v227
    v_cvt_pk_bf16_f32 v225, v226, v227
    v_add_f32 v11, v11, v228
    v_add_f32 v12, v12, v229
    v_cvt_pk_bf16_f32 v226, v228, v229
    v_add_f32 v11, v11, v230
    v_add_f32 v12, v12, v231
    v_cvt_pk_bf16_f32 v227, v230, v231
    v_add_f32 v11, v11, v232
    v_add_f32 v12, v12, v233
    v_cvt_pk_bf16_f32 v228, v232, v233
    v_add_f32 v11, v11, v234
    v_add_f32 v12, v12, v235
    v_cvt_pk_bf16_f32 v229, v234, v235
    v_add_f32 v11, v11, v236
    v_add_f32 v12, v12, v237
    v_cvt_pk_bf16_f32 v230, v236, v237
    v_add_f32 v11, v11, v238
    v_add_f32 v12, v12, v239
    v_cvt_pk_bf16_f32 v231, v238, v239
    s_cmp_lt_u32 s3, 2
    s_cbranch_scc1 L_pw_26
    ds_write_b128 v27, v[144:147] offset:4096
    ds_write_b128 v27, v[148:151] offset:5120
L_pw_26:
    s_waitcnt lgkmcnt(0)
    s_waitcnt vmcnt(12)
    s_barrier
    s_add_u32 m0, s50, 114688
    s_mov_b32 s51, 98304
    buffer_load_dwordx4 v5, s[8:11], s51 offen offset:0 nt lds
    buffer_load_dwordx4 v5, s[8:11], s51 offen offset:1024 nt lds
    buffer_load_dwordx4 v5, s[8:11], s51 offen offset:2048 nt lds
    buffer_load_dwordx4 v5, s[8:11], s51 offen offset:3072 nt lds
    s_add_u32 m0, s50, 131072
    s_mov_b32 s51, 36864
    buffer_load_dwordx4 v37, s[16:19], s51 offen  lds
    s_add_u32 m0, s50, 132096
    s_mov_b32 s51, 46080
    buffer_load_dwordx4 v37, s[16:19], s51 offen  lds
    s_add_u32 m0, s50, 133120
    s_mov_b32 s51, 55296
    buffer_load_dwordx4 v37, s[16:19], s51 offen  lds
    s_add_u32 m0, s50, 134144
    s_mov_b32 s51, 64512
    buffer_load_dwordx4 v37, s[16:19], s51 offen  lds
    v_add_u32 v17, 49152, v7
    ds_read_b128 v[52:55], v28 offset:4096
    ds_read_b64_tr_b16 v[48:49], v17 offset:0
    ds_read_b64_tr_b16 v[50:51], v17 offset:2048
    ds_read_b128 v[60:63], v28 offset:5120
    ds_read_b64_tr_b16 v[56:57], v17 offset:4096
    ds_read_b64_tr_b16 v[58:59], v17 offset:6144
    ds_read_b128 v[68:71], v28 offset:6144
    ds_read_b64_tr_b16 v[64:65], v17 offset:8192
    ds_read_b64_tr_b16 v[66:67], v17 offset:10240
    ds_read_b128 v[76:79], v28 offset:7168
    ds_read_b64_tr_b16 v[72:73], v17 offset:12288
    ds_read_b64_tr_b16 v[74:75], v17 offset:14336
    s_waitcnt lgkmcnt(9)
    v_mfma_f32_32x32x16_bf16 v[80:95], v[48:51], v[52:55], v[80:95]
    s_waitcnt lgkmcnt(6)
    v_mfma_f32_32x32x16_bf16 v[80:95], v[56:59], v[60:63], v[80:95]
    s_waitcnt lgkmcnt(3)
    v_mfma_f32_32x32x16_bf16 v[80:95], v[64:67], v[68:71], v[80:95]
    s_waitcnt lgkmcnt(0)
    v_mfma_f32_32x32x16_bf16 v[80:95], v[72:75], v[76:79], v[80:95]
    v_add_u32 v17, 32768, v39
    v_xor_b32 v18, 8192, v17
    ds_read_b64_tr_b16 a[0:1], v17 offset:0
    ds_read_b64_tr_b16 a[2:3], v17 offset:1024
    ds_read_b64_tr_b16 a[32:33], v17 offset:4096
    ds_read_b64_tr_b16 a[34:35], v17 offset:5120
    ds_read_b64_tr_b16 a[64:65], v18 offset:0
    ds_read_b64_tr_b16 a[66:67], v18 offset:1024
    ds_read_b64_tr_b16 a[96:97], v18 offset:4096
    ds_read_b64_tr_b16 a[98:99], v18 offset:5120
    v_fma_f32 v240, v240, s56, -v13
    v_fma_f32 v241, v241, s56, -v13
    v_fma_f32 v242, v242, s56, -v13
    v_fma_f32 v243, v243, s56, -v13
    v_fma_f32 v244, v244, s56, -v13
    v_fma_f32 v245, v245, s56, -v13
    v_fma_f32 v246, v246, s56, -v13
    v_fma_f32 v247, v247, s56, -v13
    v_fma_f32 v248, v248, s56, -v13
    v_fma_f32 v249, v249, s56, -v13
    v_fma_f32 v250, v250, s56, -v13
    v_fma_f32 v251, v251, s56, -v13
    v_fma_f32 v252, v252, s56, -v13
    v_fma_f32 v253, v253, s56, -v13
    v_fma_f32 v254, v254, s56, -v13
    v_fma_f32 v255, v255, s56, -v13
    v_exp_f32 v240, v240
    v_exp_f32 v241, v241
    v_exp_f32 v242, v242
    v_exp_f32 v243, v243
    v_exp_f32 v244, v244
    v_exp_f32 v245, v245
    v_exp_f32 v246, v246
    v_exp_f32 v247, v247
    v_exp_f32 v248, v248
    v_exp_f32 v249, v249
    v_exp_f32 v250, v250
    v_exp_f32 v251, v251
    v_exp_f32 v252, v252
    v_exp_f32 v253, v253
    v_exp_f32 v254, v254
    v_exp_f32 v255, v255
    v_add_f32 v11, v11, v240
    v_add_f32 v12, v12, v241
    v_cvt_pk_bf16_f32 v240, v240, v241
    v_add_f32 v11, v11, v242
    v_add_f32 v12, v12, v243
    v_cvt_pk_bf16_f32 v241, v242, v243
    v_add_f32 v11, v11, v244
    v_add_f32 v12, v12, v245
    v_cvt_pk_bf16_f32 v242, v244, v245
    v_add_f32 v11, v11, v246
    v_add_f32 v12, v12, v247
    v_cvt_pk_bf16_f32 v243, v246, v247
    v_add_f32 v11, v11, v248
    v_add_f32 v12, v12, v249
    v_cvt_pk_bf16_f32 v244, v248, v249
    v_add_f32 v11, v11, v250
    v_add_f32 v12, v12, v251
    v_cvt_pk_bf16_f32 v245, v250, v251
    v_add_f32 v11, v11, v252
    v_add_f32 v12, v12, v253
    v_cvt_pk_bf16_f32 v246, v252, v253
    v_add_f32 v11, v11, v254
    v_add_f32 v12, v12, v255
    v_cvt_pk_bf16_f32 v247, v254, v255
    s_cmp_ge_u32 s3, 2
    s_cbranch_scc1 L_pw_27
    ds_write_b128 v27, v[160:163] offset:0
    ds_write_b128 v27, v[164:167] offset:1024
L_pw_27:
    v_add_f32 v11, v11, v12
    v_mov_b32 v12, v11
    s_nop 1
    v_permlane32_swap_b32 v11, v12
    v_add_f32 v11, v11, v12
    ds_write_b32 v29, v11 offset:512
    s_waitcnt lgkmcnt(0)
    s_waitcnt vmcnt(16)
    s_barrier
    ds_read2_b32 v[18:19], v30 offset0:128 offset1:160
    ds_read2_b32 v[20:21], v30 offset0:192 offset1:224
    v_mov_b32 v44, s26
    v_cmp_gt_u32 vcc, 32, v0
    s_waitcnt lgkmcnt(0)
    v_add_f32 v18, v18, v19
    v_add_f32 v20, v20, v21
    v_add_f32 v11, v18, v20
    v_cndmask_b32 v40, v44, v13, vcc
    v_cndmask_b32 v42, v44, v11, vcc
    s_add_u32 s52, s57, 22528
    s_cmp_lg_u32 s3, 0
    s_cbranch_scc1 L_nomls
    s_cmp_eq_u32 s58, 0
    s_cbranch_scc1 L_mlloc
    buffer_store_dwordx4 v[40:43], v31, s[12:15], s52 offen sc1
    s_branch L_nomls
L_mlloc:
    buffer_store_dwordx4 v[40:43], v31, s[12:15], s52 offen
L_nomls:
    s_add_u32 m0, s50, 0
    s_mov_b32 s51, 114688
    buffer_load_dwordx4 v5, s[8:11], s51 offen offset:0 nt lds
    buffer_load_dwordx4 v5, s[8:11], s51 offen offset:1024 nt lds
    buffer_load_dwordx4 v5, s[8:11], s51 offen offset:2048 nt lds
    buffer_load_dwordx4 v5, s[8:11], s51 offen offset:3072 nt lds
    v_add_u32 v17, 65536, v7
    ds_read_b128 v[52:55], v28 offset:0
    ds_read_b64_tr_b16 v[48:49], v17 offset:0
    ds_read_b64_tr_b16 v[50:51], v17 offset:2048
    ds_read_b128 v[60:63], v28 offset:1024
    ds_read_b64_tr_b16 v[56:57], v17 offset:4096
    ds_read_b64_tr_b16 v[58:59], v17 offset:6144
    ds_read_b128 v[68:71], v28 offset:2048
    ds_read_b64_tr_b16 v[64:65], v17 offset:8192
    ds_read_b64_tr_b16 v[66:67], v17 offset:10240
    ds_read_b128 v[76:79], v28 offset:3072
    ds_read_b64_tr_b16 v[72:73], v17 offset:12288
    ds_read_b64_tr_b16 v[74:75], v17 offset:14336
    s_waitcnt lgkmcnt(9)
    v_mfma_f32_32x32x16_bf16 v[80:95], v[48:51], v[52:55], v[80:95]
    s_waitcnt lgkmcnt(6)
    v_mfma_f32_32x32x16_bf16 v[80:95], v[56:59], v[60:63], v[80:95]
    s_waitcnt lgkmcnt(3)
    v_mfma_f32_32x32x16_bf16 v[80:95], v[64:67], v[68:71], v[80:95]
    s_waitcnt lgkmcnt(0)
    v_mfma_f32_32x32x16_bf16 v[80:95], v[72:75], v[76:79], v[80:95]
    s_cmp_lt_u32 s3, 2
    s_cbranch_scc1 L_pw_28
    ds_write_b128 v27, v[160:163] offset:4096
    ds_write_b128 v27, v[164:167] offset:5120
L_pw_28:
    s_waitcnt lgkmcnt(0)
    s_waitcnt vmcnt(12)
    s_barrier
    s_add_u32 m0, s50, 16384
    s_mov_b32 s51, 131072
    buffer_load_dwordx4 v5, s[8:11], s51 offen offset:0 nt lds
    buffer_load_dwordx4 v5, s[8:11], s51 offen offset:1024 nt lds
    buffer_load_dwordx4 v5, s[8:11], s51 offen offset:2048 nt lds
    buffer_load_dwordx4 v5, s[8:11], s51 offen offset:3072 nt lds
    s_add_u32 m0, s50, 32768
    s_mov_b32 s51, 36992
    buffer_load_dwordx4 v37, s[16:19], s51 offen  lds
    s_add_u32 m0, s50, 33792
    s_mov_b32 s51, 46208
    buffer_load_dwordx4 v37, s[16:19], s51 offen  lds
    s_add_u32 m0, s50, 34816
    s_mov_b32 s51, 55424
    buffer_load_dwordx4 v37, s[16:19], s51 offen  lds
    s_add_u32 m0, s50, 35840
    s_mov_b32 s51, 64640
    buffer_load_dwordx4 v37, s[16:19], s51 offen  lds
    v_add_u32 v17, 98304, v7
    ds_read_b128 v[52:55], v28 offset:4096
    ds_read_b64_tr_b16 v[48:49], v17 offset:0
    ds_read_b64_tr_b16 v[50:51], v17 offset:2048
    ds_read_b128 v[60:63], v28 offset:5120
    ds_read_b64_tr_b16 v[56:57], v17 offset:4096
    ds_read_b64_tr_b16 v[58:59], v17 offset:6144
    ds_read_b128 v[68:71], v28 offset:6144
    ds_read_b64_tr_b16 v[64:65], v17 offset:8192
    ds_read_b64_tr_b16 v[66:67], v17 offset:10240
    ds_read_b128 v[76:79], v28 offset:7168
    ds_read_b64_tr_b16 v[72:73], v17 offset:12288
    ds_read_b64_tr_b16 v[74:75], v17 offset:14336
    s_waitcnt lgkmcnt(9)
    v_mfma_f32_32x32x16_bf16 v[80:95], v[48:51], v[52:55], v[80:95]
    s_waitcnt lgkmcnt(6)
    v_mfma_f32_32x32x16_bf16 v[80:95], v[56:59], v[60:63], v[80:95]
    s_waitcnt lgkmcnt(3)
    v_mfma_f32_32x32x16_bf16 v[80:95], v[64:67], v[68:71], v[80:95]
    s_waitcnt lgkmcnt(0)
    v_mfma_f32_32x32x16_bf16 v[80:95], v[72:75], v[76:79], v[80:95]
    v_add_u32 v17, 81920, v39
    v_xor_b32 v18, 8192, v17
    ds_read_b64_tr_b16 a[16:17], v17 offset:0
    ds_read_b64_tr_b16 a[18:19], v17 offset:1024
    ds_read_b64_tr_b16 a[48:49], v17 offset:4096
    ds_read_b64_tr_b16 a[50:51], v17 offset:5120
    ds_read_b64_tr_b16 a[80:81], v18 offset:0
    ds_read_b64_tr_b16 a[82:83], v18 offset:1024
    ds_read_b64_tr_b16 a[112:113], v18 offset:4096
    ds_read_b64_tr_b16 a[114:115], v18 offset:5120
    s_cmp_ge_u32 s3, 2
    s_cbranch_scc1 L_pw_29
    ds_write_b128 v27, v[176:179] offset:0
    ds_write_b128 v27, v[180:183] offset:1024
L_pw_29:
    s_waitcnt lgkmcnt(0)
    s_waitcnt vmcnt(16)
    s_barrier
    s_add_u32 m0, s50, 49152
    s_mov_b32 s51, 147456
    buffer_load_dwordx4 v5, s[8:11], s51 offen offset:0 nt lds
    buffer_load_dwordx4 v5, s[8:11], s51 offen offset:1024 nt lds
    buffer_load_dwordx4 v5, s[8:11], s51 offen offset:2048 nt lds
    buffer_load_dwordx4 v5, s[8:11], s51 offen offset:3072 nt lds
    v_add_u32 v17, 114688, v7
    ds_read_b128 v[52:55], v28 offset:0
    ds_read_b64_tr_b16 v[48:49], v17 offset:0
    ds_read_b64_tr_b16 v[50:51], v17 offset:2048
    ds_read_b128 v[60:63], v28 offset:1024
    ds_read_b64_tr_b16 v[56:57], v17 offset:4096
    ds_read_b64_tr_b16 v[58:59], v17 offset:6144
    ds_read_b128 v[68:71], v28 offset:2048
    ds_read_b64_tr_b16 v[64:65], v17 offset:8192
    ds_read_b64_tr_b16 v[66:67], v17 offset:10240
    ds_read_b128 v[76:79], v28 offset:3072
    ds_read_b64_tr_b16 v[72:73], v17 offset:12288
    ds_read_b64_tr_b16 v[74:75], v17 offset:14336
    s_waitcnt lgkmcnt(9)
    v_mfma_f32_32x32x16_bf16 v[80:95], v[48:51], v[52:55], v[80:95]
    s_waitcnt lgkmcnt(6)
    v_mfma_f32_32x32x16_bf16 v[80:95], v[56:59], v[60:63], v[80:95]
    s_waitcnt lgkmcnt(3)
    v_mfma_f32_32x32x16_bf16 v[80:95], v[64:67], v[68:71], v[80:95]
    s_waitcnt lgkmcnt(0)
    v_mfma_f32_32x32x16_bf16 v[80:95], v[72:75], v[76:79], v[80:95]
    s_cmp_lt_u32 s3, 2
    s_cbranch_scc1 L_pw_30
    ds_write_b128 v27, v[176:179] offset:4096
    ds_write_b128 v27, v[180:183] offset:5120
L_pw_30:
    s_waitcnt lgkmcnt(0)
    s_waitcnt vmcnt(12)
    s_barrier
    s_add_u32 m0, s50, 65536
    s_mov_b32 s51, 163840
    buffer_load_dwordx4 v5, s[8:11], s51 offen offset:0 nt lds
    buffer_load_dwordx4 v5, s[8:11], s51 offen offset:1024 nt lds
    buffer_load_dwordx4 v5, s[8:11], s51 offen offset:2048 nt lds
    buffer_load_dwordx4 v5, s[8:11], s51 offen offset:3072 nt lds
    s_add_u32 m0, s50, 81920
    s_mov_b32 s51, 73728
    buffer_load_dwordx4 v37, s[16:19], s51 offen  lds
    s_add_u32 m0, s50, 82944
    s_mov_b32 s51, 82944
    buffer_load_dwordx4 v37, s[16:19], s51 offen  lds
    s_add_u32 m0, s50, 83968
    s_mov_b32 s51, 92160
    buffer_load_dwordx4 v37, s[16:19], s51 offen  lds
    s_add_u32 m0, s50, 84992
    s_mov_b32 s51, 101376
    buffer_load_dwordx4 v37, s[16:19], s51 offen  lds
    v_add_u32 v17, 0, v7
    ds_read_b128 v[52:55], v28 offset:4096
    ds_read_b64_tr_b16 v[48:49], v17 offset:0
    ds_read_b64_tr_b16 v[50:51], v17 offset:2048
    ds_read_b128 v[60:63], v28 offset:5120
    ds_read_b64_tr_b16 v[56:57], v17 offset:4096
    ds_read_b64_tr_b16 v[58:59], v17 offset:6144
    ds_read_b128 v[68:71], v28 offset:6144
    ds_read_b64_tr_b16 v[64:65], v17 offset:8192
    ds_read_b64_tr_b16 v[66:67], v17 offset:10240
    ds_read_b128 v[76:79], v28 offset:7168
    ds_read_b64_tr_b16 v[72:73], v17 offset:12288
    ds_read_b64_tr_b16 v[74:75], v17 offset:14336
    s_waitcnt lgkmcnt(9)
    v_mfma_f32_32x32x16_bf16 v[80:95], v[48:51], v[52:55], v[80:95]
    s_waitcnt lgkmcnt(6)
    v_mfma_f32_32x32x16_bf16 v[80:95], v[56:59], v[60:63], v[80:95]
    s_waitcnt lgkmcnt(3)
    v_mfma_f32_32x32x16_bf16 v[80:95], v[64:67], v[68:71], v[80:95]
    s_waitcnt lgkmcnt(0)
    v_mfma_f32_32x32x16_bf16 v[80:95], v[72:75], v[76:79], v[80:95]
    v_add_u32 v17, 131072, v39
    v_xor_b32 v18, 8192, v17
    ds_read_b64_tr_b16 a[4:5], v17 offset:0
    ds_read_b64_tr_b16 a[6:7], v17 offset:1024
    ds_read_b64_tr_b16 a[36:37], v17 offset:4096
    ds_read_b64_tr_b16 a[38:39], v17 offset:5120
    ds_read_b64_tr_b16 a[68:69], v18 offset:0
    ds_read_b64_tr_b16 a[70:71], v18 offset:1024
    ds_read_b64_tr_b16 a[100:101], v18 offset:4096
    ds_read_b64_tr_b16 a[102:103], v18 offset:5120
    s_cmp_ge_u32 s3, 2
    s_cbranch_scc1 L_pw_31
    ds_write_b128 v27, v[192:195] offset:0
    ds_write_b128 v27, v[196:199] offset:1024
L_pw_31:
    s_waitcnt lgkmcnt(0)
    s_waitcnt vmcnt(16)
    s_barrier
    s_add_u32 m0, s50, 98304
    s_mov_b32 s51, 180224
    buffer_load_dwordx4 v5, s[8:11], s51 offen offset:0 nt lds
    buffer_load_dwordx4 v5, s[8:11], s51 offen offset:1024 nt lds
    buffer_load_dwordx4 v5, s[8:11], s51 offen offset:2048 nt lds
    buffer_load_dwordx4 v5, s[8:11], s51 offen offset:3072 nt lds
    v_add_u32 v17, 16384, v7
    ds_read_b128 v[52:55], v28 offset:0
    ds_read_b64_tr_b16 v[48:49], v17 offset:0
    ds_read_b64_tr_b16 v[50:51], v17 offset:2048
    ds_read_b128 v[60:63], v28 offset:1024
    ds_read_b64_tr_b16 v[56:57], v17 offset:4096
    ds_read_b64_tr_b16 v[58:59], v17 offset:6144
    ds_read_b128 v[68:71], v28 offset:2048
    ds_read_b64_tr_b16 v[64:65], v17 offset:8192
    ds_read_b64_tr_b16 v[66:67], v17 offset:10240
    ds_read_b128 v[76:79], v28 offset:3072
    ds_read_b64_tr_b16 v[72:73], v17 offset:12288
    ds_read_b64_tr_b16 v[74:75], v17 offset:14336
    s_waitcnt lgkmcnt(9)
    v_mfma_f32_32x32x16_bf16 v[80:95], v[48:51], v[52:55], v[80:95]
    s_waitcnt lgkmcnt(6)
    v_mfma_f32_32x32x16_bf16 v[80:95], v[56:59], v[60:63], v[80:95]
    s_waitcnt lgkmcnt(3)
    v_mfma_f32_32x32x16_bf16 v[80:95], v[64:67], v[68:71], v[80:95]
    s_waitcnt lgkmcnt(0)
    v_mfma_f32_32x32x16_bf16 v[80:95], v[72:75], v[76:79], v[80:95]
    s_cmp_lt_u32 s3, 2
    s_cbranch_scc1 L_pw_32
    ds_write_b128 v27, v[192:195] offset:4096
    ds_write_b128 v27, v[196:199] offset:5120
L_pw_32:
    s_waitcnt lgkmcnt(0)
    s_waitcnt vmcnt(12)
    s_barrier
    s_add_u32 s52, s63, 22528
    buffer_load_dwordx4 v[44:47], v26, s[12:15], s52 offen sc1
    s_add_u32 m0, s50, 114688
    s_mov_b32 s51, 196608
    buffer_load_dwordx4 v5, s[8:11], s51 offen offset:0 nt lds
    buffer_load_dwordx4 v5, s[8:11], s51 offen offset:1024 nt lds
    buffer_load_dwordx4 v5, s[8:11], s51 offen offset:2048 nt lds
    buffer_load_dwordx4 v5, s[8:11], s51 offen offset:3072 nt lds
    s_add_u32 m0, s50, 131072
    s_mov_b32 s51, 73856
    buffer_load_dwordx4 v37, s[16:19], s51 offen  lds
    s_add_u32 m0, s50, 132096
    s_mov_b32 s51, 83072
    buffer_load_dwordx4 v37, s[16:19], s51 offen  lds
    s_add_u32 m0, s50, 133120
    s_mov_b32 s51, 92288
    buffer_load_dwordx4 v37, s[16:19], s51 offen  lds
    s_add_u32 m0, s50, 134144
    s_mov_b32 s51, 101504
    buffer_load_dwordx4 v37, s[16:19], s51 offen  lds
    v_add_u32 v17, 49152, v7
    ds_read_b128 v[52:55], v28 offset:4096
    ds_read_b64_tr_b16 v[48:49], v17 offset:0
    ds_read_b64_tr_b16 v[50:51], v17 offset:2048
    ds_read_b128 v[60:63], v28 offset:5120
    ds_read_b64_tr_b16 v[56:57], v17 offset:4096
    ds_read_b64_tr_b16 v[58:59], v17 offset:6144
    ds_read_b128 v[68:71], v28 offset:6144
    ds_read_b64_tr_b16 v[64:65], v17 offset:8192
    ds_read_b64_tr_b16 v[66:67], v17 offset:10240
    ds_read_b128 v[76:79], v28 offset:7168
    ds_read_b64_tr_b16 v[72:73], v17 offset:12288
    ds_read_b64_tr_b16 v[74:75], v17 offset:14336
    s_waitcnt lgkmcnt(9)
    v_mfma_f32_32x32x16_bf16 v[80:95], v[48:51], v[52:55], v[80:95]
    s_waitcnt lgkmcnt(6)
    v_mfma_f32_32x32x16_bf16 v[80:95], v[56:59], v[60:63], v[80:95]
    s_waitcnt lgkmcnt(3)
    v_mfma_f32_32x32x16_bf16 v[80:95], v[64:67], v[68:71], v[80:95]
    s_waitcnt lgkmcnt(0)
    v_mfma_f32_32x32x16_bf16 v[80:95], v[72:75], v[76:79], v[80:95]
    v_add_u32 v17, 32768, v39
    v_xor_b32 v18, 8192, v17
    ds_read_b64_tr_b16 a[20:21], v17 offset:0
    ds_read_b64_tr_b16 a[22:23], v17 offset:1024
    ds_read_b64_tr_b16 a[52:53], v17 offset:4096
    ds_read_b64_tr_b16 a[54:55], v17 offset:5120
    ds_read_b64_tr_b16 a[84:85], v18 offset:0
    ds_read_b64_tr_b16 a[86:87], v18 offset:1024
    ds_read_b64_tr_b16 a[116:117], v18 offset:4096
    ds_read_b64_tr_b16 a[118:119], v18 offset:5120
    s_cmp_ge_u32 s3, 2
    s_cbranch_scc1 L_pw_33
    ds_write_b128 v27, v[208:211] offset:0
    ds_write_b128 v27, v[212:215] offset:1024
L_pw_33:
    s_waitcnt lgkmcnt(0)
    s_waitcnt vmcnt(17)
    s_barrier
    s_add_u32 m0, s50, 0
    s_mov_b32 s51, 212992
    buffer_load_dwordx4 v5, s[8:11], s51 offen offset:0 nt lds
    buffer_load_dwordx4 v5, s[8:11], s51 offen offset:1024 nt lds
    buffer_load_dwordx4 v5, s[8:11], s51 offen offset:2048 nt lds
    buffer_load_dwordx4 v5, s[8:11], s51 offen offset:3072 nt lds
    v_add_u32 v17, 65536, v7
    ds_read_b128 v[52:55], v28 offset:0
    ds_read_b64_tr_b16 v[48:49], v17 offset:0
    ds_read_b64_tr_b16 v[50:51], v17 offset:2048
    ds_read_b128 v[60:63], v28 offset:1024
    ds_read_b64_tr_b16 v[56:57], v17 offset:4096
    ds_read_b64_tr_b16 v[58:59], v17 offset:6144
    ds_read_b128 v[68:71], v28 offset:2048
    ds_read_b64_tr_b16 v[64:65], v17 offset:8192
    ds_read_b64_tr_b16 v[66:67], v17 offset:10240
    ds_read_b128 v[76:79], v28 offset:3072
    ds_read_b64_tr_b16 v[72:73], v17 offset:12288
    ds_read_b64_tr_b16 v[74:75], v17 offset:14336
    s_waitcnt lgkmcnt(9)
    v_mfma_f32_32x32x16_bf16 v[80:95], v[48:51], v[52:55], v[80:95]
    s_waitcnt lgkmcnt(6)
    v_mfma_f32_32x32x16_bf16 v[80:95], v[56:59], v[60:63], v[80:95]
    s_waitcnt lgkmcnt(3)
    v_mfma_f32_32x32x16_bf16 v[80:95], v[64:67], v[68:71], v[80:95]
    s_waitcnt lgkmcnt(0)
    v_mfma_f32_32x32x16_bf16 v[80:95], v[72:75], v[76:79], v[80:95]
    s_cmp_lt_u32 s3, 2
    s_cbranch_scc1 L_pw_34
    ds_write_b128 v27, v[208:211] offset:4096
    ds_write_b128 v27, v[212:215] offset:5120
L_pw_34:
    s_waitcnt lgkmcnt(0)
    s_waitcnt vmcnt(13)
    s_barrier
    s_add_u32 m0, s50, 16384
    s_mov_b32 s51, 229376
    buffer_load_dwordx4 v5, s[8:11], s51 offen offset:0 nt lds
    buffer_load_dwordx4 v5, s[8:11], s51 offen offset:1024 nt lds
    buffer_load_dwordx4 v5, s[8:11], s51 offen offset:2048 nt lds
    buffer_load_dwordx4 v5, s[8:11], s51 offen offset:3072 nt lds
    s_add_u32 m0, s50, 32768
    s_mov_b32 s51, 245760
    buffer_load_dwordx4 v5, s[8:11], s51 offen offset:0 nt lds
    buffer_load_dwordx4 v5, s[8:11], s51 offen offset:1024 nt lds
    buffer_load_dwordx4 v5, s[8:11], s51 offen offset:2048 nt lds
    buffer_load_dwordx4 v5, s[8:11], s51 offen offset:3072 nt lds
    v_add_u32 v17, 98304, v7
    ds_read_b128 v[52:55], v28 offset:4096
    ds_read_b64_tr_b16 v[48:49], v17 offset:0
    ds_read_b64_tr_b16 v[50:51], v17 offset:2048
    ds_read_b128 v[60:63], v28 offset:5120
    ds_read_b64_tr_b16 v[56:57], v17 offset:4096
    ds_read_b64_tr_b16 v[58:59], v17 offset:6144
    ds_read_b128 v[68:71], v28 offset:6144
    ds_read_b64_tr_b16 v[64:65], v17 offset:8192
    ds_read_b64_tr_b16 v[66:67], v17 offset:10240
    ds_read_b128 v[76:79], v28 offset:7168
    ds_read_b64_tr_b16 v[72:73], v17 offset:12288
    ds_read_b64_tr_b16 v[74:75], v17 offset:14336
    s_waitcnt lgkmcnt(9)
    v_mfma_f32_32x32x16_bf16 v[80:95], v[48:51], v[52:55], v[80:95]
    s_waitcnt lgkmcnt(6)
    v_mfma_f32_32x32x16_bf16 v[80:95], v[56:59], v[60:63], v[80:95]
    s_waitcnt lgkmcnt(3)
    v_mfma_f32_32x32x16_bf16 v[80:95], v[64:67], v[68:71], v[80:95]
    s_waitcnt lgkmcnt(0)
    v_mfma_f32_32x32x16_bf16 v[80:95], v[72:75], v[76:79], v[80:95]
    v_add_u32 v17, 81920, v39
    v_xor_b32 v18, 8192, v17
    ds_read_b64_tr_b16 a[8:9], v17 offset:0
    ds_read_b64_tr_b16 a[10:11], v17 offset:1024
    ds_read_b64_tr_b16 a[40:41], v17 offset:4096
    ds_read_b64_tr_b16 a[42:43], v17 offset:5120
    ds_read_b64_tr_b16 a[72:73], v18 offset:0
    ds_read_b64_tr_b16 a[74:75], v18 offset:1024
    ds_read_b64_tr_b16 a[104:105], v18 offset:4096
    ds_read_b64_tr_b16 a[106:107], v18 offset:5120
    s_cmp_ge_u32 s3, 2
    s_cbranch_scc1 L_pw_35
    ds_write_b128 v27, v[224:227] offset:0
    ds_write_b128 v27, v[228:231] offset:1024
L_pw_35:
    s_waitcnt lgkmcnt(0)
    s_waitcnt vmcnt(16)
    s_barrier
    s_add_u32 m0, s50, 49152
    s_mov_b32 s51, 110592
    buffer_load_dwordx4 v37, s[16:19], s51 offen  lds
    s_add_u32 m0, s50, 50176
    s_mov_b32 s51, 119808
    buffer_load_dwordx4 v37, s[16:19], s51 offen  lds
    s_add_u32 m0, s50, 51200
    s_mov_b32 s51, 129024
    buffer_load_dwordx4 v37, s[16:19], s51 offen  lds
    s_add_u32 m0, s50, 52224
    s_mov_b32 s51, 138240
    buffer_load_dwordx4 v37, s[16:19], s51 offen  lds
    v_add_u32 v17, 114688, v7
    ds_read_b128 v[52:55], v28 offset:0
    ds_read_b64_tr_b16 v[48:49], v17 offset:0
    ds_read_b64_tr_b16 v[50:51], v17 offset:2048
    ds_read_b128 v[60:63], v28 offset:1024
    ds_read_b64_tr_b16 v[56:57], v17 offset:4096
    ds_read_b64_tr_b16 v[58:59], v17 offset:6144
    ds_read_b128 v[68:71], v28 offset:2048
    ds_read_b64_tr_b16 v[64:65], v17 offset:8192
    ds_read_b64_tr_b16 v[66:67], v17 offset:10240
    ds_read_b128 v[76:79], v28 offset:3072
    ds_read_b64_tr_b16 v[72:73], v17 offset:12288
    ds_read_b64_tr_b16 v[74:75], v17 offset:14336
    s_waitcnt lgkmcnt(9)
    v_mfma_f32_32x32x16_bf16 v[80:95], v[48:51], v[52:55], v[80:95]
    s_waitcnt lgkmcnt(6)
    v_mfma_f32_32x32x16_bf16 v[80:95], v[56:59], v[60:63], v[80:95]
    s_waitcnt lgkmcnt(3)
    v_mfma_f32_32x32x16_bf16 v[80:95], v[64:67], v[68:71], v[80:95]
    s_waitcnt lgkmcnt(0)
    v_mfma_f32_32x32x16_bf16 v[80:95], v[72:75], v[76:79], v[80:95]
    s_cmp_lt_u32 s3, 2
    s_cbranch_scc1 L_pw_36
    ds_write_b128 v27, v[224:227] offset:4096
    ds_write_b128 v27, v[228:231] offset:5120
L_pw_36:
    s_waitcnt lgkmcnt(0)
    s_waitcnt vmcnt(12)
    s_barrier
    s_add_u32 m0, s50, 65536
    s_mov_b32 s51, 110720
    buffer_load_dwordx4 v37, s[16:19], s51 offen  lds
    s_add_u32 m0, s50, 66560
    s_mov_b32 s51, 119936
    buffer_load_dwordx4 v37, s[16:19], s51 offen  lds
    s_add_u32 m0, s50, 67584
    s_mov_b32 s51, 129152
    buffer_load_dwordx4 v37, s[16:19], s51 offen  lds
    s_add_u32 m0, s50, 68608
    s_mov_b32 s51, 138368
    buffer_load_dwordx4 v37, s[16:19], s51 offen  lds
    v_add_u32 v17, 0, v7
    ds_read_b128 v[52:55], v28 offset:4096
    ds_read_b64_tr_b16 v[48:49], v17 offset:0
    ds_read_b64_tr_b16 v[50:51], v17 offset:2048
    ds_read_b128 v[60:63], v28 offset:5120
    ds_read_b64_tr_b16 v[56:57], v17 offset:4096
    ds_read_b64_tr_b16 v[58:59], v17 offset:6144
    ds_read_b128 v[68:71], v28 offset:6144
    ds_read_b64_tr_b16 v[64:65], v17 offset:8192
    ds_read_b64_tr_b16 v[66:67], v17 offset:10240
    ds_read_b128 v[76:79], v28 offset:7168
    ds_read_b64_tr_b16 v[72:73], v17 offset:12288
    ds_read_b64_tr_b16 v[74:75], v17 offset:14336
    s_waitcnt lgkmcnt(9)
    v_mfma_f32_32x32x16_bf16 v[80:95], v[48:51], v[52:55], v[80:95]
    s_waitcnt lgkmcnt(6)
    v_mfma_f32_32x32x16_bf16 v[80:95], v[56:59], v[60:63], v[80:95]
    s_waitcnt lgkmcnt(3)
    v_mfma_f32_32x32x16_bf16 v[80:95], v[64:67], v[68:71], v[80:95]
    s_waitcnt lgkmcnt(0)
    v_mfma_f32_32x32x16_bf16 v[80:95], v[72:75], v[76:79], v[80:95]
    v_add_u32 v17, 131072, v39
    v_xor_b32 v18, 8192, v17
    ds_read_b64_tr_b16 a[24:25], v17 offset:0
    ds_read_b64_tr_b16 a[26:27], v17 offset:1024
    ds_read_b64_tr_b16 a[56:57], v17 offset:4096
    ds_read_b64_tr_b16 a[58:59], v17 offset:5120
    ds_read_b64_tr_b16 a[88:89], v18 offset:0
    ds_read_b64_tr_b16 a[90:91], v18 offset:1024
    ds_read_b64_tr_b16 a[120:121], v18 offset:4096
    ds_read_b64_tr_b16 a[122:123], v18 offset:5120
    s_cmp_ge_u32 s3, 2
    s_cbranch_scc1 L_pw_37
    ds_write_b128 v27, v[240:243] offset:0
    ds_write_b128 v27, v[244:247] offset:1024
L_pw_37:
    v_xor_b32 v17, v14, v45
    v_bitop3_b32 v17, v17, v47, v14 bitop3:0xf6
    v_cmp_ne_u32 vcc, 0, v17
    s_nop 1
    s_cbranch_vccz L_ml_ok_38
    s_mov_b32 s59, 0
L_ml_re_39:
    s_add_u32 s52, s63, 22528
    buffer_load_dwordx4 v[44:47], v26, s[12:15], s52 offen sc1
    s_waitcnt vmcnt(0)
    s_add_u32 s59, s59, 1
    s_cmp_gt_u32 s59, 65536
    s_cbranch_scc1 L_ml_ok_38
    v_xor_b32 v17, v14, v45
    v_bitop3_b32 v17, v17, v47, v14 bitop3:0xf6
    v_cmp_ne_u32 vcc, 0, v17
    s_nop 1
    s_cbranch_vccnz L_ml_re_39
L_ml_ok_38:
    v_cmp_ne_u32 vcc, s26, v44
    v_mov_b32 v18, v44
    v_mov_b32 v19, v46
    s_mov_b32 s58, vcc_hi
    v_permlane32_swap_b32 v44, v18
    v_permlane32_swap_b32 v46, v19
    v_max_f32 v18, v13, v44
    v_sub_f32 v19, v13, v18
    v_sub_f32 v20, v44, v18
    v_exp_f32 v19, v19
    v_exp_f32 v20, v20
    s_nop 0
    v_mul_f32 v18, v19, v11
    v_fma_f32 v18, v20, v46, v18
    v_rcp_f32 v18, v18
    s_nop 0
    v_mul_f32 v10, v19, v18
    s_waitcnt lgkmcnt(0)
    s_waitcnt vmcnt(12)
    s_barrier
    v_add_u32 v17, 16384, v7
    ds_read_b128 v[52:55], v28 offset:0
    ds_read_b64_tr_b16 v[48:49], v17 offset:0
    ds_read_b64_tr_b16 v[50:51], v17 offset:2048
    ds_read_b128 v[60:63], v28 offset:1024
    ds_read_b64_tr_b16 v[56:57], v17 offset:4096
    ds_read_b64_tr_b16 v[58:59], v17 offset:6144
    ds_read_b128 v[68:71], v28 offset:2048
    ds_read_b64_tr_b16 v[64:65], v17 offset:8192
    ds_read_b64_tr_b16 v[66:67], v17 offset:10240
    ds_read_b128 v[76:79], v28 offset:3072
    ds_read_b64_tr_b16 v[72:73], v17 offset:12288
    ds_read_b64_tr_b16 v[74:75], v17 offset:14336
    s_waitcnt lgkmcnt(9)
    v_mfma_f32_32x32x16_bf16 v[80:95], v[48:51], v[52:55], v[80:95]
    s_waitcnt lgkmcnt(6)
    v_mfma_f32_32x32x16_bf16 v[80:95], v[56:59], v[60:63], v[80:95]
    s_waitcnt lgkmcnt(3)
    v_mfma_f32_32x32x16_bf16 v[80:95], v[64:67], v[68:71], v[80:95]
    s_waitcnt lgkmcnt(0)
    v_mfma_f32_32x32x16_bf16 v[80:95], v[72:75], v[76:79], v[80:95]
    s_cmp_lt_u32 s3, 2
    s_cbranch_scc1 L_pw_40
    ds_write_b128 v27, v[240:243] offset:4096
    ds_write_b128 v27, v[244:247] offset:5120
L_pw_40:
    s_lshl_b32 s54, s3, 11
    s_add_u32 s62, s57, s54
    s_add_u32 s55, s54, 0
    v_add_u32 v33, s55, v8
    v_add_u32 v32, 0, v32
    s_lshl_b32 s55, s48, 11
    v_add_u32 v34, s55, v32
    s_xor_b32 s52, s48, 1
    s_mul_i32 s52, s52, 23552
    s_add_u32 s52, s52, s63
    s_add_u32 s60, s52, s54
    s_xor_b32 s52, s48, 2
    s_mul_i32 s52, s52, 23552
    s_add_u32 s52, s52, s63
    s_add_u32 s61, s52, s54
    s_xor_b32 s52, s48, 3
    s_mul_i32 s52, s52, 23552
    s_add_u32 s52, s52, s63
    s_add_u32 s44, s52, s54
    s_mul_i32 s25, s3, 4294965760
    s_add_u32 s25, s25, 8192
    v_lshlrev_b32 v26, 3, v0
    v_add_u32 v26, s25, v26
    s_lshl_b32 s52, s3, 2
    s_add_u32 s52, s52, 156672
    v_mov_b32 v29, s52
    v_mov_b32 v30, 156672
    s_waitcnt lgkmcnt(0)
    s_waitcnt vmcnt(8)
    s_barrier
    v_add_u32 v17, 32768, v7
    ds_read_b128 v[52:55], v28 offset:4096
    ds_read_b64_tr_b16 v[48:49], v17 offset:0
    ds_read_b64_tr_b16 v[50:51], v17 offset:2048
    ds_read_b128 v[60:63], v28 offset:5120
    ds_read_b64_tr_b16 v[56:57], v17 offset:4096
    ds_read_b64_tr_b16 v[58:59], v17 offset:6144
    ds_read_b128 v[68:71], v28 offset:6144
    ds_read_b64_tr_b16 v[64:65], v17 offset:8192
    ds_read_b64_tr_b16 v[66:67], v17 offset:10240
    ds_read_b128 v[76:79], v28 offset:7168
    ds_read_b64_tr_b16 v[72:73], v17 offset:12288
    ds_read_b64_tr_b16 v[74:75], v17 offset:14336
    s_waitcnt lgkmcnt(9)
    v_mfma_f32_32x32x16_bf16 v[80:95], v[48:51], v[52:55], v[80:95]
    s_waitcnt lgkmcnt(6)
    v_mfma_f32_32x32x16_bf16 v[80:95], v[56:59], v[60:63], v[80:95]
    s_waitcnt lgkmcnt(3)
    v_mfma_f32_32x32x16_bf16 v[80:95], v[64:67], v[68:71], v[80:95]
    s_waitcnt lgkmcnt(0)
    v_mfma_f32_32x32x16_bf16 v[80:95], v[72:75], v[76:79], v[80:95]
L_tail0:
    s_cmp_eq_u32 s58, 0
    s_nop 10
    v_pk_mul_f32 v[80:81], v[80:81], v[10:11] op_sel_hi:[1,0]
    v_pk_mul_f32 v[82:83], v[82:83], v[10:11] op_sel_hi:[1,0]
    v_pk_mul_f32 v[84:85], v[84:85], v[10:11] op_sel_hi:[1,0]
    v_pk_mul_f32 v[86:87], v[86:87], v[10:11] op_sel_hi:[1,0]
    v_pk_mul_f32 v[88:89], v[88:89], v[10:11] op_sel_hi:[1,0]
    v_pk_mul_f32 v[90:91], v[90:91], v[10:11] op_sel_hi:[1,0]
    v_pk_mul_f32 v[92:93], v[92:93], v[10:11] op_sel_hi:[1,0]
    v_pk_mul_f32 v[94:95], v[94:95], v[10:11] op_sel_hi:[1,0]
    v_cvt_pk_bf16_f32 v248, v80, v81
    v_cvt_pk_bf16_f32 v249, v82, v83
    v_cvt_pk_bf16_f32 v250, v84, v85
    v_cvt_pk_bf16_f32 v251, v86, v87
    v_cvt_pk_bf16_f32 v252, v88, v89
    v_cvt_pk_bf16_f32 v253, v90, v91
    v_cvt_pk_bf16_f32 v254, v92, v93
    v_cvt_pk_bf16_f32 v255, v94, v95
    s_cbranch_scc1 L_os_41
    buffer_store_dwordx4 v[248:251], v8, s[12:15], s62 offen offset:0 sc1
    buffer_store_dwordx4 v[252:255], v8, s[12:15], s62 offen offset:1024 sc1
    v_alignbit_b32 v18, v249, v249, 5
    v_alignbit_b32 v19, v250, v250, 11
    v_add3_u32 v18, v248, v18, v19
    v_alignbit_b32 v19, v251, v251, 19
    v_add3_u32 v22, v18, v19, v14
    v_alignbit_b32 v18, v253, v253, 5
    v_alignbit_b32 v19, v254, v254, 11
    v_add3_u32 v18, v252, v18, v19
    v_alignbit_b32 v19, v255, v255, 19
    v_add3_u32 v23, v18, v19, v14
    buffer_store_dwordx2 v[22:23], v26, s[12:15], s62 offen sc1
    s_branch L_os_42
L_os_41:
    buffer_store_dwordx4 v[248:251], v8, s[12:15], s62 offen offset:0
    buffer_store_dwordx4 v[252:255], v8, s[12:15], s62 offen offset:1024
    v_alignbit_b32 v18, v249, v249, 5
    v_alignbit_b32 v19, v250, v250, 11
    v_add3_u32 v18, v248, v18, v19
    v_alignbit_b32 v19, v251, v251, 19
    v_add3_u32 v22, v18, v19, v14
    v_alignbit_b32 v18, v253, v253, 5
    v_alignbit_b32 v19, v254, v254, 11
    v_add3_u32 v18, v252, v18, v19
    v_alignbit_b32 v19, v255, v255, 19
    v_add3_u32 v23, v18, v19, v14
    buffer_store_dwordx2 v[22:23], v26, s[12:15], s62 offen
L_os_42:
    buffer_load_dwordx4 v[96:99], v8, s[12:15], s60 offen offset:0 sc1
    buffer_load_dwordx4 v[100:103], v8, s[12:15], s60 offen offset:1024 sc1
    buffer_load_dwordx2 v[104:105], v26, s[12:15], s60 offen sc1
    buffer_load_dwordx4 v[106:109], v8, s[12:15], s61 offen offset:0 sc1
    buffer_load_dwordx4 v[110:113], v8, s[12:15], s61 offen offset:1024 sc1
    buffer_load_dwordx2 v[114:115], v26, s[12:15], s61 offen sc1
    buffer_load_dwordx4 v[116:119], v8, s[12:15], s44 offen offset:0 sc1
    buffer_load_dwordx4 v[120:123], v8, s[12:15], s44 offen offset:1024 sc1
    buffer_load_dwordx2 v[124:125], v26, s[12:15], s44 offen sc1
    ds_write_b128 v33, v[248:251] offset:0
    ds_write_b128 v33, v[252:255] offset:1024
    s_lshl_b32 s62, s3, 7
    s_add_u32 s62, s62, s57
    s_add_u32 s62, s62, 10240
    s_mov_b32 s25, 0xff
    s_mov_b32 s59, 0
    s_waitcnt vmcnt(12)
    s_mov_b32 s58, 14
    s_mov_b32 s55, 1
    s_waitcnt lgkmcnt(0)
    s_barrier
    v_add_u32 v17, 49152, v39
    v_xor_b32 v18, 8192, v17
    ds_read_b64_tr_b16 a[12:13], v17 offset:0
    ds_read_b64_tr_b16 a[14:15], v17 offset:1024
    ds_read_b64_tr_b16 a[44:45], v17 offset:4096
    ds_read_b64_tr_b16 a[46:47], v17 offset:5120
    ds_read_b64_tr_b16 a[76:77], v18 offset:0
    ds_read_b64_tr_b16 a[78:79], v18 offset:1024
    ds_read_b64_tr_b16 a[108:109], v18 offset:4096
    ds_read_b64_tr_b16 a[110:111], v18 offset:5120
    v_add_u32 v17, 65536, v39
    v_xor_b32 v18, 8192, v17
    ds_read_b64_tr_b16 a[28:29], v17 offset:0
    ds_read_b64_tr_b16 a[30:31], v17 offset:1024
    ds_read_b64_tr_b16 a[60:61], v17 offset:4096
    ds_read_b64_tr_b16 a[62:63], v17 offset:5120
    ds_read_b64_tr_b16 a[92:93], v18 offset:0
    ds_read_b64_tr_b16 a[94:95], v18 offset:1024
    ds_read_b64_tr_b16 a[124:125], v18 offset:4096
    ds_read_b64_tr_b16 a[126:127], v18 offset:5120
    s_waitcnt lgkmcnt(0)
    ds_read_b128 v[128:131], v32 offset:0
    ds_read_b128 v[132:135], v32 offset:2048
    ds_read_b128 v[136:139], v32 offset:4096
    ds_read_b128 v[140:143], v32 offset:6144
    ds_read_b128 v[160:163], v34 offset:0
    ds_read_b128 v[144:147], v32 offset:256
    ds_read_b128 v[148:151], v32 offset:2304
    ds_read_b128 v[152:155], v32 offset:4352
    ds_read_b128 v[156:159], v32 offset:6400
    ds_read_b128 v[164:167], v34 offset:256
    s_waitcnt lgkmcnt(9)
    v_mfma_f32_16x16x32_bf16 v[48:51], a[0:3], v[128:131], 0
    v_mfma_f32_16x16x32_bf16 v[52:55], a[16:19], v[128:131], 0
    s_waitcnt lgkmcnt(8)
    v_mfma_f32_16x16x32_bf16 v[48:51], a[4:7], v[132:135], v[48:51]
    v_mfma_f32_16x16x32_bf16 v[52:55], a[20:23], v[132:135], v[52:55]
    s_waitcnt lgkmcnt(7)
    v_mfma_f32_16x16x32_bf16 v[48:51], a[8:11], v[136:139], v[48:51]
    v_mfma_f32_16x16x32_bf16 v[52:55], a[24:27], v[136:139], v[52:55]
    s_waitcnt lgkmcnt(6)
    v_mfma_f32_16x16x32_bf16 v[48:51], a[12:15], v[140:143], v[48:51]
    v_mfma_f32_16x16x32_bf16 v[52:55], a[28:31], v[140:143], v[52:55]
    s_waitcnt lgkmcnt(5)
    v_mfma_f32_16x16x32_bf16 v[56:59], a[128:131], v[160:163], 0
    s_waitcnt lgkmcnt(4)
    v_mfma_f32_16x16x32_bf16 v[48:51], a[32:35], v[144:147], v[48:51]
    v_mfma_f32_16x16x32_bf16 v[52:55], a[48:51], v[144:147], v[52:55]
    s_waitcnt lgkmcnt(3)
    v_mfma_f32_16x16x32_bf16 v[48:51], a[36:39], v[148:151], v[48:51]
    v_mfma_f32_16x16x32_bf16 v[52:55], a[52:55], v[148:151], v[52:55]
    s_waitcnt lgkmcnt(2)
    v_mfma_f32_16x16x32_bf16 v[48:51], a[40:43], v[152:155], v[48:51]
    v_mfma_f32_16x16x32_bf16 v[52:55], a[56:59], v[152:155], v[52:55]
    s_waitcnt lgkmcnt(1)
    v_mfma_f32_16x16x32_bf16 v[48:51], a[44:47], v[156:159], v[48:51]
    v_mfma_f32_16x16x32_bf16 v[52:55], a[60:63], v[156:159], v[52:55]
    s_waitcnt lgkmcnt(0)
    v_mfma_f32_16x16x32_bf16 v[56:59], a[132:135], v[164:167], v[56:59]
L_o_chk:
    s_waitcnt vmcnt(0)
    s_bitcmp1_b32 s55, 1
    s_cbranch_scc1 L_oc_43
    v_alignbit_b32 v17, v97, v97, 5
    v_alignbit_b32 v19, v98, v98, 11
    v_add3_u32 v17, v96, v17, v19
    v_alignbit_b32 v19, v99, v99, 19
    v_add3_u32 v17, v17, v19, v14
    v_alignbit_b32 v18, v101, v101, 5
    v_alignbit_b32 v19, v102, v102, 11
    v_add3_u32 v18, v100, v18, v19
    v_alignbit_b32 v19, v103, v103, 19
    v_add3_u32 v18, v18, v19, v14
    v_xor_b32 v17, v17, v104
    v_bitop3_b32 v17, v17, v18, v105 bitop3:0xf6
    v_cmp_ne_u32 vcc, 0, v17
    ds_write_b128 v33, v[96:99] offset:8192
    ds_write_b128 v33, v[100:103] offset:9216
    s_bitset1_b32 s55, 1
    s_cbranch_vccz L_oc_43
    s_bitset0_b32 s55, 1
    buffer_load_dwordx4 v[96:99], v8, s[12:15], s60 offen offset:0 sc1
    buffer_load_dwordx4 v[100:103], v8, s[12:15], s60 offen offset:1024 sc1
    buffer_load_dwordx2 v[104:105], v26, s[12:15], s60 offen sc1
L_oc_43:
    s_bitcmp1_b32 s55, 2
    s_cbranch_scc1 L_oc_45
    v_alignbit_b32 v17, v107, v107, 5
    v_alignbit_b32 v19, v108, v108, 11
    v_add3_u32 v17, v106, v17, v19
    v_alignbit_b32 v19, v109, v109, 19
    v_add3_u32 v17, v17, v19, v14
    v_alignbit_b32 v18, v111, v111, 5
    v_alignbit_b32 v19, v112, v112, 11
    v_add3_u32 v18, v110, v18, v19
    v_alignbit_b32 v19, v113, v113, 19
    v_add3_u32 v18, v18, v19, v14
    v_xor_b32 v17, v17, v114
    v_bitop3_b32 v17, v17, v18, v115 bitop3:0xf6
    v_cmp_ne_u32 vcc, 0, v17
    ds_write_b128 v33, v[106:109] offset:16384
    ds_write_b128 v33, v[110:113] offset:17408
    s_bitset1_b32 s55, 2
    s_cbranch_vccz L_oc_45
    s_bitset0_b32 s55, 2
    buffer_load_dwordx4 v[106:109], v8, s[12:15], s61 offen offset:0 sc1
    buffer_load_dwordx4 v[110:113], v8, s[12:15], s61 offen offset:1024 sc1
    buffer_load_dwordx2 v[114:115], v26, s[12:15], s61 offen sc1
L_oc_45:
    s_bitcmp1_b32 s55, 3
    s_cbranch_scc1 L_oc_47
    v_alignbit_b32 v17, v117, v117, 5
    v_alignbit_b32 v19, v118, v118, 11
    v_add3_u32 v17, v116, v17, v19
    v_alignbit_b32 v19, v119, v119, 19
    v_add3_u32 v17, v17, v19, v14
    v_alignbit_b32 v18, v121, v121, 5
    v_alignbit_b32 v19, v122, v122, 11
    v_add3_u32 v18, v120, v18, v19
    v_alignbit_b32 v19, v123, v123, 19
    v_add3_u32 v18, v18, v19, v14
    v_xor_b32 v17, v17, v124
    v_bitop3_b32 v17, v17, v18, v125 bitop3:0xf6
    v_cmp_ne_u32 vcc, 0, v17
    ds_write_b128 v33, v[116:119] offset:24576
    ds_write_b128 v33, v[120:123] offset:25600
    s_bitset1_b32 s55, 3
    s_cbranch_vccz L_oc_47
    s_bitset0_b32 s55, 3
    buffer_load_dwordx4 v[116:119], v8, s[12:15], s44 offen offset:0 sc1
    buffer_load_dwordx4 v[120:123], v8, s[12:15], s44 offen offset:1024 sc1
    buffer_load_dwordx2 v[124:125], v26, s[12:15], s44 offen sc1
L_oc_47:
    v_mov_b32 v17, s55
    ds_write_b32 v29, v17
    v_xor_b32 v29, 16, v29
    s_waitcnt lgkmcnt(0)
    s_barrier
    ds_read_b128 v[18:21], v30
    v_xor_b32 v30, 16, v30
    s_add_u32 s59, s59, 1
    s_waitcnt lgkmcnt(0)
    v_and_b32 v18, v18, v19
    v_bitop3_b32 v18, v18, v20, v21 bitop3:0x80
    s_cmp_gt_u32 s59, 65536
    v_readfirstlane_b32 s52, v18
    s_cselect_b32 s52, 15, s52
    s_and_b32 s52, s52, s58
    s_andn2_b32 s58, s58, s52
    s_cmp_eq_u32 s52, 14
    s_cbranch_scc1 L_o_all
L_o_blk:
    s_bitcmp1_b32 s52, 1
    s_cbranch_scc0 L_ob_49
    ds_read_b128 v[128:131], v32 offset:8192
    ds_read_b128 v[132:135], v32 offset:10240
    ds_read_b128 v[136:139], v32 offset:12288
    ds_read_b128 v[140:143], v32 offset:14336
    ds_read_b128 v[160:163], v34 offset:8192
    ds_read_b128 v[144:147], v32 offset:8448
    ds_read_b128 v[148:151], v32 offset:10496
    ds_read_b128 v[152:155], v32 offset:12544
    ds_read_b128 v[156:159], v32 offset:14592
    ds_read_b128 v[164:167], v34 offset:8448
    s_waitcnt lgkmcnt(9)
    v_mfma_f32_16x16x32_bf16 v[60:63], a[64:67], v[128:131], 0
    v_mfma_f32_16x16x32_bf16 v[64:67], a[80:83], v[128:131], 0
    s_waitcnt lgkmcnt(8)
    v_mfma_f32_16x16x32_bf16 v[60:63], a[68:71], v[132:135], v[60:63]
    v_mfma_f32_16x16x32_bf16 v[64:67], a[84:87], v[132:135], v[64:67]
    s_waitcnt lgkmcnt(7)
    v_mfma_f32_16x16x32_bf16 v[60:63], a[72:75], v[136:139], v[60:63]
    v_mfma_f32_16x16x32_bf16 v[64:67], a[88:91], v[136:139], v[64:67]
    s_waitcnt lgkmcnt(6)
    v_mfma_f32_16x16x32_bf16 v[60:63], a[76:79], v[140:143], v[60:63]
    v_mfma_f32_16x16x32_bf16 v[64:67], a[92:95], v[140:143], v[64:67]
    s_waitcnt lgkmcnt(5)
    v_mfma_f32_16x16x32_bf16 v[68:71], a[136:139], v[160:163], 0
    s_waitcnt lgkmcnt(4)
    v_mfma_f32_16x16x32_bf16 v[60:63], a[96:99], v[144:147], v[60:63]
    v_mfma_f32_16x16x32_bf16 v[64:67], a[112:115], v[144:147], v[64:67]
    s_waitcnt lgkmcnt(3)
    v_mfma_f32_16x16x32_bf16 v[60:63], a[100:103], v[148:151], v[60:63]
    v_mfma_f32_16x16x32_bf16 v[64:67], a[116:119], v[148:151], v[64:67]
    s_waitcnt lgkmcnt(2)
    v_mfma_f32_16x16x32_bf16 v[60:63], a[104:107], v[152:155], v[60:63]
    v_mfma_f32_16x16x32_bf16 v[64:67], a[120:123], v[152:155], v[64:67]
    s_waitcnt lgkmcnt(1)
    v_mfma_f32_16x16x32_bf16 v[60:63], a[108:111], v[156:159], v[60:63]
    v_mfma_f32_16x16x32_bf16 v[64:67], a[124:127], v[156:159], v[64:67]
    s_waitcnt lgkmcnt(0)
    v_mfma_f32_16x16x32_bf16 v[68:71], a[140:143], v[164:167], v[68:71]
L_ob_49:
    s_bitcmp1_b32 s52, 2
    s_cbranch_scc0 L_ob_50
    ds_read_b128 v[128:131], v32 offset:16384
    ds_read_b128 v[132:135], v32 offset:18432
    ds_read_b128 v[136:139], v32 offset:20480
    ds_read_b128 v[140:143], v32 offset:22528
    ds_read_b128 v[160:163], v34 offset:16384
    ds_read_b128 v[144:147], v32 offset:16640
    ds_read_b128 v[148:151], v32 offset:18688
    ds_read_b128 v[152:155], v32 offset:20736
    ds_read_b128 v[156:159], v32 offset:22784
    ds_read_b128 v[164:167], v34 offset:16640
    s_waitcnt lgkmcnt(9)
    v_mfma_f32_16x16x32_bf16 v[72:75], a[0:3], v[128:131], 0
    v_mfma_f32_16x16x32_bf16 v[76:79], a[16:19], v[128:131], 0
    s_waitcnt lgkmcnt(8)
    v_mfma_f32_16x16x32_bf16 v[72:75], a[4:7], v[132:135], v[72:75]
    v_mfma_f32_16x16x32_bf16 v[76:79], a[20:23], v[132:135], v[76:79]
    s_waitcnt lgkmcnt(7)
    v_mfma_f32_16x16x32_bf16 v[72:75], a[8:11], v[136:139], v[72:75]
    v_mfma_f32_16x16x32_bf16 v[76:79], a[24:27], v[136:139], v[76:79]
    s_waitcnt lgkmcnt(6)
    v_mfma_f32_16x16x32_bf16 v[72:75], a[12:15], v[140:143], v[72:75]
    v_mfma_f32_16x16x32_bf16 v[76:79], a[28:31], v[140:143], v[76:79]
    s_waitcnt lgkmcnt(5)
    v_mfma_f32_16x16x32_bf16 v[80:83], a[128:131], v[160:163], 0
    s_waitcnt lgkmcnt(4)
    v_mfma_f32_16x16x32_bf16 v[72:75], a[32:35], v[144:147], v[72:75]
    v_mfma_f32_16x16x32_bf16 v[76:79], a[48:51], v[144:147], v[76:79]
    s_waitcnt lgkmcnt(3)
    v_mfma_f32_16x16x32_bf16 v[72:75], a[36:39], v[148:151], v[72:75]
    v_mfma_f32_16x16x32_bf16 v[76:79], a[52:55], v[148:151], v[76:79]
    s_waitcnt lgkmcnt(2)
    v_mfma_f32_16x16x32_bf16 v[72:75], a[40:43], v[152:155], v[72:75]
    v_mfma_f32_16x16x32_bf16 v[76:79], a[56:59], v[152:155], v[76:79]
    s_waitcnt lgkmcnt(1)
    v_mfma_f32_16x16x32_bf16 v[72:75], a[44:47], v[156:159], v[72:75]
    v_mfma_f32_16x16x32_bf16 v[76:79], a[60:63], v[156:159], v[76:79]
    s_waitcnt lgkmcnt(0)
    v_mfma_f32_16x16x32_bf16 v[80:83], a[132:135], v[164:167], v[80:83]
L_ob_50:
    s_bitcmp1_b32 s52, 3
    s_cbranch_scc0 L_ob_51
    ds_read_b128 v[128:131], v32 offset:24576
    ds_read_b128 v[132:135], v32 offset:26624
    ds_read_b128 v[136:139], v32 offset:28672
    ds_read_b128 v[140:143], v32 offset:30720
    ds_read_b128 v[160:163], v34 offset:24576
    ds_read_b128 v[144:147], v32 offset:24832
    ds_read_b128 v[148:151], v32 offset:26880
    ds_read_b128 v[152:155], v32 offset:28928
    ds_read_b128 v[156:159], v32 offset:30976
    ds_read_b128 v[164:167], v34 offset:24832
    s_waitcnt lgkmcnt(9)
    v_mfma_f32_16x16x32_bf16 v[84:87], a[64:67], v[128:131], 0
    v_mfma_f32_16x16x32_bf16 v[88:91], a[80:83], v[128:131], 0
    s_waitcnt lgkmcnt(8)
    v_mfma_f32_16x16x32_bf16 v[84:87], a[68:71], v[132:135], v[84:87]
    v_mfma_f32_16x16x32_bf16 v[88:91], a[84:87], v[132:135], v[88:91]
    s_waitcnt lgkmcnt(7)
    v_mfma_f32_16x16x32_bf16 v[84:87], a[72:75], v[136:139], v[84:87]
    v_mfma_f32_16x16x32_bf16 v[88:91], a[88:91], v[136:139], v[88:91]
    s_waitcnt lgkmcnt(6)
    v_mfma_f32_16x16x32_bf16 v[84:87], a[76:79], v[140:143], v[84:87]
    v_mfma_f32_16x16x32_bf16 v[88:91], a[92:95], v[140:143], v[88:91]
    s_waitcnt lgkmcnt(5)
    v_mfma_f32_16x16x32_bf16 v[92:95], a[136:139], v[160:163], 0
    s_waitcnt lgkmcnt(4)
    v_mfma_f32_16x16x32_bf16 v[84:87], a[96:99], v[144:147], v[84:87]
    v_mfma_f32_16x16x32_bf16 v[88:91], a[112:115], v[144:147], v[88:91]
    s_waitcnt lgkmcnt(3)
    v_mfma_f32_16x16x32_bf16 v[84:87], a[100:103], v[148:151], v[84:87]
    v_mfma_f32_16x16x32_bf16 v[88:91], a[116:119], v[148:151], v[88:91]
    s_waitcnt lgkmcnt(2)
    v_mfma_f32_16x16x32_bf16 v[84:87], a[104:107], v[152:155], v[84:87]
    v_mfma_f32_16x16x32_bf16 v[88:91], a[120:123], v[152:155], v[88:91]
    s_waitcnt lgkmcnt(1)
    v_mfma_f32_16x16x32_bf16 v[84:87], a[108:111], v[156:159], v[84:87]
    v_mfma_f32_16x16x32_bf16 v[88:91], a[124:127], v[156:159], v[88:91]
    s_waitcnt lgkmcnt(0)
    v_mfma_f32_16x16x32_bf16 v[92:95], a[140:143], v[164:167], v[92:95]
L_ob_51:
    s_cmp_eq_u32 s58, 0
    s_cbranch_scc1 L_o_done
    s_branch L_o_chk
L_o_all:
    ds_read_b128 v[128:131], v32 offset:8192
    ds_read_b128 v[132:135], v32 offset:10240
    ds_read_b128 v[136:139], v32 offset:12288
    ds_read_b128 v[140:143], v32 offset:14336
    ds_read_b128 v[160:163], v34 offset:8192
    ds_read_b128 v[144:147], v32 offset:8448
    ds_read_b128 v[148:151], v32 offset:10496
    ds_read_b128 v[152:155], v32 offset:12544
    ds_read_b128 v[156:159], v32 offset:14592
    ds_read_b128 v[164:167], v34 offset:8448
    s_waitcnt lgkmcnt(9)
    v_mfma_f32_16x16x32_bf16 v[60:63], a[64:67], v[128:131], 0
    v_mfma_f32_16x16x32_bf16 v[64:67], a[80:83], v[128:131], 0
    ds_read_b128 v[168:171], v32 offset:16384
    s_waitcnt lgkmcnt(9)
    v_mfma_f32_16x16x32_bf16 v[60:63], a[68:71], v[132:135], v[60:63]
    v_mfma_f32_16x16x32_bf16 v[64:67], a[84:87], v[132:135], v[64:67]
    ds_read_b128 v[172:175], v32 offset:18432
    s_waitcnt lgkmcnt(9)
    v_mfma_f32_16x16x32_bf16 v[60:63], a[72:75], v[136:139], v[60:63]
    v_mfma_f32_16x16x32_bf16 v[64:67], a[88:91], v[136:139], v[64:67]
    ds_read_b128 v[176:179], v32 offset:20480
    s_waitcnt lgkmcnt(9)
    v_mfma_f32_16x16x32_bf16 v[60:63], a[76:79], v[140:143], v[60:63]
    v_mfma_f32_16x16x32_bf16 v[64:67], a[92:95], v[140:143], v[64:67]
    ds_read_b128 v[180:183], v32 offset:22528
    s_waitcnt lgkmcnt(9)
    v_mfma_f32_16x16x32_bf16 v[68:71], a[136:139], v[160:163], 0
    ds_read_b128 v[200:203], v34 offset:16384
    s_waitcnt lgkmcnt(9)
    v_mfma_f32_16x16x32_bf16 v[60:63], a[96:99], v[144:147], v[60:63]
    v_mfma_f32_16x16x32_bf16 v[64:67], a[112:115], v[144:147], v[64:67]
    ds_read_b128 v[184:187], v32 offset:16640
    s_waitcnt lgkmcnt(9)
    v_mfma_f32_16x16x32_bf16 v[60:63], a[100:103], v[148:151], v[60:63]
    v_mfma_f32_16x16x32_bf16 v[64:67], a[116:119], v[148:151], v[64:67]
    ds_read_b128 v[188:191], v32 offset:18688
    s_waitcnt lgkmcnt(9)
    v_mfma_f32_16x16x32_bf16 v[60:63], a[104:107], v[152:155], v[60:63]
    v_mfma_f32_16x16x32_bf16 v[64:67], a[120:123], v[152:155], v[64:67]
    ds_read_b128 v[192:195], v32 offset:20736
    s_waitcnt lgkmcnt(9)
    v_mfma_f32_16x16x32_bf16 v[60:63], a[108:111], v[156:159], v[60:63]
    v_mfma_f32_16x16x32_bf16 v[64:67], a[124:127], v[156:159], v[64:67]
    ds_read_b128 v[196:199], v32 offset:22784
    s_waitcnt lgkmcnt(9)
    v_mfma_f32_16x16x32_bf16 v[68:71], a[140:143], v[164:167], v[68:71]
    ds_read_b128 v[204:207], v34 offset:16640
    s_waitcnt lgkmcnt(9)
    v_mfma_f32_16x16x32_bf16 v[72:75], a[0:3], v[168:171], 0
    v_mfma_f32_16x16x32_bf16 v[76:79], a[16:19], v[168:171], 0
    ds_read_b128 v[208:211], v32 offset:24576
    s_waitcnt lgkmcnt(9)
    v_mfma_f32_16x16x32_bf16 v[72:75], a[4:7], v[172:175], v[72:75]
    v_mfma_f32_16x16x32_bf16 v[76:79], a[20:23], v[172:175], v[76:79]
    ds_read_b128 v[212:215], v32 offset:26624
    s_waitcnt lgkmcnt(9)
    v_mfma_f32_16x16x32_bf16 v[72:75], a[8:11], v[176:179], v[72:75]
    v_mfma_f32_16x16x32_bf16 v[76:79], a[24:27], v[176:179], v[76:79]
    ds_read_b128 v[216:219], v32 offset:28672
    s_waitcnt lgkmcnt(9)
    v_mfma_f32_16x16x32_bf16 v[72:75], a[12:15], v[180:183], v[72:75]
    v_mfma_f32_16x16x32_bf16 v[76:79], a[28:31], v[180:183], v[76:79]
    ds_read_b128 v[220:223], v32 offset:30720
    s_waitcnt lgkmcnt(9)
    v_mfma_f32_16x16x32_bf16 v[80:83], a[128:131], v[200:203], 0
    ds_read_b128 v[240:243], v34 offset:24576
    s_waitcnt lgkmcnt(9)
    v_mfma_f32_16x16x32_bf16 v[72:75], a[32:35], v[184:187], v[72:75]
    v_mfma_f32_16x16x32_bf16 v[76:79], a[48:51], v[184:187], v[76:79]
    ds_read_b128 v[224:227], v32 offset:24832
    s_waitcnt lgkmcnt(9)
    v_mfma_f32_16x16x32_bf16 v[72:75], a[36:39], v[188:191], v[72:75]
    v_mfma_f32_16x16x32_bf16 v[76:79], a[52:55], v[188:191], v[76:79]
    ds_read_b128 v[228:231], v32 offset:26880
    s_waitcnt lgkmcnt(9)
    v_mfma_f32_16x16x32_bf16 v[72:75], a[40:43], v[192:195], v[72:75]
    v_mfma_f32_16x16x32_bf16 v[76:79], a[56:59], v[192:195], v[76:79]
    ds_read_b128 v[232:235], v32 offset:28928
    s_waitcnt lgkmcnt(9)
    v_mfma_f32_16x16x32_bf16 v[72:75], a[44:47], v[196:199], v[72:75]
    v_mfma_f32_16x16x32_bf16 v[76:79], a[60:63], v[196:199], v[76:79]
    ds_read_b128 v[236:239], v32 offset:30976
    s_waitcnt lgkmcnt(9)
    v_mfma_f32_16x16x32_bf16 v[80:83], a[132:135], v[204:207], v[80:83]
    ds_read_b128 v[244:247], v34 offset:24832
    s_waitcnt lgkmcnt(9)
    v_mfma_f32_16x16x32_bf16 v[84:87], a[64:67], v[208:211], 0
    v_mfma_f32_16x16x32_bf16 v[88:91], a[80:83], v[208:211], 0
    s_waitcnt lgkmcnt(8)
    v_mfma_f32_16x16x32_bf16 v[84:87], a[68:71], v[212:215], v[84:87]
    v_mfma_f32_16x16x32_bf16 v[88:91], a[84:87], v[212:215], v[88:91]
    s_waitcnt lgkmcnt(7)
    v_mfma_f32_16x16x32_bf16 v[84:87], a[72:75], v[216:219], v[84:87]
    v_mfma_f32_16x16x32_bf16 v[88:91], a[88:91], v[216:219], v[88:91]
    s_waitcnt lgkmcnt(6)
    v_mfma_f32_16x16x32_bf16 v[84:87], a[76:79], v[220:223], v[84:87]
    v_mfma_f32_16x16x32_bf16 v[88:91], a[92:95], v[220:223], v[88:91]
    s_waitcnt lgkmcnt(5)
    v_mfma_f32_16x16x32_bf16 v[92:95], a[136:139], v[240:243], 0
    s_waitcnt lgkmcnt(4)
    v_mfma_f32_16x16x32_bf16 v[84:87], a[96:99], v[224:227], v[84:87]
    v_mfma_f32_16x16x32_bf16 v[88:91], a[112:115], v[224:227], v[88:91]
    s_waitcnt lgkmcnt(3)
    v_mfma_f32_16x16x32_bf16 v[84:87], a[100:103], v[228:231], v[84:87]
    v_mfma_f32_16x16x32_bf16 v[88:91], a[116:119], v[228:231], v[88:91]
    s_waitcnt lgkmcnt(2)
    v_mfma_f32_16x16x32_bf16 v[84:87], a[104:107], v[232:235], v[84:87]
    v_mfma_f32_16x16x32_bf16 v[88:91], a[120:123], v[232:235], v[88:91]
    s_waitcnt lgkmcnt(1)
    v_mfma_f32_16x16x32_bf16 v[84:87], a[108:111], v[236:239], v[84:87]
    v_mfma_f32_16x16x32_bf16 v[88:91], a[124:127], v[236:239], v[88:91]
    s_waitcnt lgkmcnt(0)
    v_mfma_f32_16x16x32_bf16 v[92:95], a[140:143], v[244:247], v[92:95]
L_o_done:
    s_nop 6
    v_pk_add_f32 v[48:49], v[48:49], v[60:61]
    v_pk_add_f32 v[50:51], v[50:51], v[62:63]
    v_pk_add_f32 v[72:73], v[72:73], v[84:85]
    v_pk_add_f32 v[74:75], v[74:75], v[86:87]
    v_pk_add_f32 v[48:49], v[48:49], v[72:73]
    v_pk_add_f32 v[50:51], v[50:51], v[74:75]
    v_bfi_b32 v48, s25, v14, v48
    v_bfi_b32 v49, s25, v14, v49
    v_bfi_b32 v50, s25, v14, v50
    v_bfi_b32 v51, s25, v14, v51
    buffer_store_dwordx4 v[48:51], v35, s[12:15], s62 offen offset:0 sc1
    v_pk_add_f32 v[52:53], v[52:53], v[64:65]
    v_pk_add_f32 v[54:55], v[54:55], v[66:67]
    v_pk_add_f32 v[76:77], v[76:77], v[88:89]
    v_pk_add_f32 v[78:79], v[78:79], v[90:91]
    v_pk_add_f32 v[52:53], v[52:53], v[76:77]
    v_pk_add_f32 v[54:55], v[54:55], v[78:79]
    v_bfi_b32 v52, s25, v14, v52
    v_bfi_b32 v53, s25, v14, v53
    v_bfi_b32 v54, s25, v14, v54
    v_bfi_b32 v55, s25, v14, v55
    buffer_store_dwordx4 v[52:55], v35, s[12:15], s62 offen offset:512 sc1
    v_pk_add_f32 v[56:57], v[56:57], v[68:69]
    v_pk_add_f32 v[58:59], v[58:59], v[70:71]
    v_pk_add_f32 v[80:81], v[80:81], v[92:93]
    v_pk_add_f32 v[82:83], v[82:83], v[94:95]
    v_pk_add_f32 v[56:57], v[56:57], v[80:81]
    v_pk_add_f32 v[58:59], v[58:59], v[82:83]
    v_bfi_b32 v56, s25, v14, v56
    v_bfi_b32 v57, s25, v14, v57
    v_bfi_b32 v58, s25, v14, v58
    v_bfi_b32 v59, s25, v14, v59
    buffer_store_dwordx4 v[56:59], v35, s[12:15], s62 offen offset:1024 sc1
    s_cmp_ge_u32 s3, 2
    s_cbranch_scc1 L_fin
    v_and_b32 v14, 0xff, v14
    s_mul_i32 s53, s28, 1536
    s_lshl_b32 s54, s30, 4
    s_lshl_b32 s55, s28, 1
    s_add_u32 s54, s54, s55
    s_cmp_eq_u32 s3, 1
    s_cbranch_scc1 L_x2
    s_mul_i32 s52, s29, 23552
    s_add_u32 s52, s52, s53
    s_add_u32 s60, s52, 1386496
    s_mul_i32 s54, s54, 1152
    s_lshl_b32 s55, s48, 8
    s_add_u32 s54, s54, s55
    v_bfe_u32 v19, v0, 2, 1
    v_mul_u32_u24 v19, 1152, v19
    v_lshrrev_b32 v20, 3, v0
    v_lshl_add_u32 v19, v20, 5, v19
    v_and_b32 v20, 3, v0
    v_lshl_add_u32 v19, v20, 3, v19
    s_waitcnt vmcnt(0)
    s_mov_b32 s52, s60
    buffer_load_dwordx4 v[128:131], v8, s[12:15], s52 offen sc1
    s_add_u32 s52, s52, 753664
    buffer_load_dwordx4 v[132:135], v8, s[12:15], s52 offen sc1
    s_add_u32 s52, s52, 753664
    buffer_load_dwordx4 v[136:139], v8, s[12:15], s52 offen sc1
    s_add_u32 s52, s52, 753664
    buffer_load_dwordx4 v[140:143], v8, s[12:15], s52 offen sc1
    s_add_u32 s52, s52, 753664
    buffer_load_dwordx4 v[144:147], v8, s[12:15], s52 offen sc1
    s_add_u32 s52, s52, 753664
    buffer_load_dwordx4 v[148:151], v8, s[12:15], s52 offen sc1
    s_add_u32 s52, s52, 753664
    buffer_load_dwordx4 v[152:155], v8, s[12:15], s52 offen sc1
    s_add_u32 s52, s52, 753664
    buffer_load_dwordx4 v[156:159], v8, s[12:15], s52 offen sc1
    s_mov_b32 s59, 0
L_y_52:
    s_waitcnt vmcnt(0)
    v_xor_b32 v128, v14, v128
    v_xor_b32 v129, v14, v129
    v_xor_b32 v130, v14, v130
    v_xor_b32 v131, v14, v131
    v_xor_b32 v132, v14, v132
    v_xor_b32 v133, v14, v133
    v_xor_b32 v134, v14, v134
    v_xor_b32 v135, v14, v135
    v_xor_b32 v136, v14, v136
    v_xor_b32 v137, v14, v137
    v_xor_b32 v138, v14, v138
    v_xor_b32 v139, v14, v139
    v_xor_b32 v140, v14, v140
    v_xor_b32 v141, v14, v141
    v_xor_b32 v142, v14, v142
    v_xor_b32 v143, v14, v143
    v_xor_b32 v144, v14, v144
    v_xor_b32 v145, v14, v145
    v_xor_b32 v146, v14, v146
    v_xor_b32 v147, v14, v147
    v_xor_b32 v148, v14, v148
    v_xor_b32 v149, v14, v149
    v_xor_b32 v150, v14, v150
    v_xor_b32 v151, v14, v151
    v_xor_b32 v152, v14, v152
    v_xor_b32 v153, v14, v153
    v_xor_b32 v154, v14, v154
    v_xor_b32 v155, v14, v155
    v_xor_b32 v156, v14, v156
    v_xor_b32 v157, v14, v157
    v_xor_b32 v158, v14, v158
    v_xor_b32 v159, v14, v159
    v_or3_b32 v17, v128, v129, v130
    v_or3_b32 v18, v131, v132, v133
    v_or3_b32 v17, v17, v134, v135
    v_or3_b32 v18, v18, v136, v137
    v_or3_b32 v17, v17, v138, v139
    v_or3_b32 v18, v18, v140, v141
    v_or3_b32 v17, v17, v142, v143
    v_or3_b32 v18, v18, v144, v145
    v_or3_b32 v17, v17, v146, v147
    v_or3_b32 v18, v18, v148, v149
    v_or3_b32 v17, v17, v150, v151
    v_or3_b32 v18, v18, v152, v153
    v_or3_b32 v17, v17, v154, v155
    v_or3_b32 v18, v18, v156, v157
    v_or3_b32 v17, v17, v158, v159
    v_bitop3_b32 v17, v17, v18, s25 bitop3:0xa8
    v_cmp_ne_u32 vcc, 0, v17
    s_add_u32 s59, s59, 1
    s_cmp_gt_u32 s59, 65536
    s_cbranch_vccz L_y_53
    s_cbranch_scc1 L_y_53
    s_mov_b32 s52, s60
    buffer_load_dwordx4 v[128:131], v8, s[12:15], s52 offen sc1
    s_add_u32 s52, s52, 753664
    buffer_load_dwordx4 v[132:135], v8, s[12:15], s52 offen sc1
    s_add_u32 s52, s52, 753664
    buffer_load_dwordx4 v[136:139], v8, s[12:15], s52 offen sc1
    s_add_u32 s52, s52, 753664
    buffer_load_dwordx4 v[140:143], v8, s[12:15], s52 offen sc1
    s_add_u32 s52, s52, 753664
    buffer_load_dwordx4 v[144:147], v8, s[12:15], s52 offen sc1
    s_add_u32 s52, s52, 753664
    buffer_load_dwordx4 v[148:151], v8, s[12:15], s52 offen sc1
    s_add_u32 s52, s52, 753664
    buffer_load_dwordx4 v[152:155], v8, s[12:15], s52 offen sc1
    s_add_u32 s52, s52, 753664
    buffer_load_dwordx4 v[156:159], v8, s[12:15], s52 offen sc1
    s_branch L_y_52
L_y_53:
    v_pk_add_f32 v[128:129], v[128:129], v[132:133]
    v_pk_add_f32 v[130:131], v[130:131], v[134:135]
    v_pk_add_f32 v[136:137], v[136:137], v[140:141]
    v_pk_add_f32 v[138:139], v[138:139], v[142:143]
    v_pk_add_f32 v[144:145], v[144:145], v[148:149]
    v_pk_add_f32 v[146:147], v[146:147], v[150:151]
    v_pk_add_f32 v[152:153], v[152:153], v[156:157]
    v_pk_add_f32 v[154:155], v[154:155], v[158:159]
    v_pk_add_f32 v[128:129], v[128:129], v[136:137]
    v_pk_add_f32 v[130:131], v[130:131], v[138:139]
    v_pk_add_f32 v[144:145], v[144:145], v[152:153]
    v_pk_add_f32 v[146:147], v[146:147], v[154:155]
    v_pk_add_f32 v[128:129], v[128:129], v[144:145]
    v_pk_add_f32 v[130:131], v[130:131], v[146:147]
    v_cvt_pk_bf16_f32 v128, v128, v129
    v_cvt_pk_bf16_f32 v129, v130, v131
    buffer_store_dwordx2 v[128:129], v19, s[20:23], s54 offen
    s_and_b32 s52, s2, 63
    s_cmp_lg_u32 s52, 0
    s_cbranch_scc1 L_fin
    s_lshl_b32 s52, s2, 2
    v_mov_b32 v14, s24
    buffer_store_dword v14, v16, s[12:15], s52 offen sc1
    s_branch L_fin
L_x2:
    s_andn2_b32 s52, s29, 3
    s_mul_i32 s52, s52, 23552
    s_add_u32 s52, s52, s53
    s_and_b32 s53, s48, 1
    s_lshl_b32 s55, s53, 8
    s_add_u32 s52, s52, s55
    s_lshr_b32 s55, s48, 1
    s_add_u32 s54, s54, s55
    s_lshl_b32 s55, s55, 6
    s_add_u32 s52, s52, s55
    s_add_u32 s60, s52, 1387520
    v_lshrrev_b32 v20, 3, v0
    s_mov_b32 s55, 753664
    v_mul_lo_u32 v20, v20, s55
    v_bfe_u32 v19, v0, 2, 1
    v_lshl_add_u32 v20, v19, 7, v20
    v_and_b32 v19, 3, v0
    v_lshl_add_u32 v20, v19, 4, v20
    s_mul_i32 s54, s54, 1152
    s_lshl_b32 s53, s53, 6
    s_add_u32 s54, s54, s53
    s_add_u32 s54, s54, 1024
    v_and_b32 v19, 7, v0
    v_lshlrev_b32 v19, 3, v19
    s_waitcnt vmcnt(0)
    s_mov_b32 s52, s60
    buffer_load_dwordx4 v[128:131], v20, s[12:15], s52 offen sc1
    s_add_u32 s52, s52, 23552
    buffer_load_dwordx4 v[132:135], v20, s[12:15], s52 offen sc1
    s_add_u32 s52, s52, 23552
    buffer_load_dwordx4 v[136:139], v20, s[12:15], s52 offen sc1
    s_add_u32 s52, s52, 23552
    buffer_load_dwordx4 v[140:143], v20, s[12:15], s52 offen sc1
    s_mov_b32 s59, 0
L_x_54:
    s_waitcnt vmcnt(0)
    v_xor_b32 v128, v14, v128
    v_xor_b32 v129, v14, v129
    v_xor_b32 v130, v14, v130
    v_xor_b32 v131, v14, v131
    v_xor_b32 v132, v14, v132
    v_xor_b32 v133, v14, v133
    v_xor_b32 v134, v14, v134
    v_xor_b32 v135, v14, v135
    v_xor_b32 v136, v14, v136
    v_xor_b32 v137, v14, v137
    v_xor_b32 v138, v14, v138
    v_xor_b32 v139, v14, v139
    v_xor_b32 v140, v14, v140
    v_xor_b32 v141, v14, v141
    v_xor_b32 v142, v14, v142
    v_xor_b32 v143, v14, v143
    v_or3_b32 v17, v128, v129, v130
    v_or3_b32 v18, v131, v132, v133
    v_or3_b32 v17, v17, v134, v135
    v_or3_b32 v18, v18, v136, v137
    v_or3_b32 v17, v17, v138, v139
    v_or3_b32 v18, v18, v140, v141
    v_or3_b32 v17, v17, v142, v143
    v_bitop3_b32 v17, v17, v18, s25 bitop3:0xa8
    v_cmp_ne_u32 vcc, 0, v17
    s_add_u32 s59, s59, 1
    s_cmp_gt_u32 s59, 65536
    s_cbranch_vccz L_x_55
    s_cbranch_scc1 L_x_55
    s_mov_b32 s52, s60
    buffer_load_dwordx4 v[128:131], v20, s[12:15], s52 offen sc1
    s_add_u32 s52, s52, 23552
    buffer_load_dwordx4 v[132:135], v20, s[12:15], s52 offen sc1
    s_add_u32 s52, s52, 23552
    buffer_load_dwordx4 v[136:139], v20, s[12:15], s52 offen sc1
    s_add_u32 s52, s52, 23552
    buffer_load_dwordx4 v[140:143], v20, s[12:15], s52 offen sc1
    s_branch L_x_54
L_x_55:
    v_pk_add_f32 v[128:129], v[128:129], v[132:133]
    v_pk_add_f32 v[130:131], v[130:131], v[134:135]
    v_pk_add_f32 v[136:137], v[136:137], v[140:141]
    v_pk_add_f32 v[138:139], v[138:139], v[142:143]
    v_pk_add_f32 v[128:129], v[128:129], v[136:137]
    v_pk_add_f32 v[130:131], v[130:131], v[138:139]
    s_nop 1
    v_add_f32_dpp v128, v128, v128 row_ror:8 row_mask:0xf bank_mask:0xf
    v_add_f32_dpp v129, v129, v129 row_ror:8 row_mask:0xf bank_mask:0xf
    v_add_f32_dpp v130, v130, v130 row_ror:8 row_mask:0xf bank_mask:0xf
    v_add_f32_dpp v131, v131, v131 row_ror:8 row_mask:0xf bank_mask:0xf
    v_mov_b32 v132, v128
    v_mov_b32 v133, v129
    v_mov_b32 v134, v130
    v_mov_b32 v135, v131
    s_nop 1
    v_permlane16_swap_b32 v128, v132
    v_permlane16_swap_b32 v129, v133
    v_permlane16_swap_b32 v130, v134
    v_permlane16_swap_b32 v131, v135
    v_add_f32 v128, v128, v132
    v_add_f32 v129, v129, v133
    v_add_f32 v130, v130, v134
    v_add_f32 v131, v131, v135
    v_mov_b32 v132, v128
    v_mov_b32 v133, v129
    v_mov_b32 v134, v130
    v_mov_b32 v135, v131
    s_nop 1
    v_permlane32_swap_b32 v128, v132
    v_permlane32_swap_b32 v129, v133
    v_permlane32_swap_b32 v130, v134
    v_permlane32_swap_b32 v131, v135
    v_add_f32 v128, v128, v132
    v_add_f32 v129, v129, v133
    v_add_f32 v130, v130, v134
    v_add_f32 v131, v131, v135
    v_cvt_pk_bf16_f32 v128, v128, v129
    v_cvt_pk_bf16_f32 v129, v130, v131
    s_mov_b64 exec, 0xff
    buffer_store_dwordx2 v[128:129], v19, s[20:23], s54 offen
L_fin:
L_end:
s_endpgm
.section .rodata,"a"
.p2align 6
.amdhsa_kernel standalone__sliding_block_cached__sampling_kernel
  .amdhsa_next_free_vgpr 512
  .amdhsa_next_free_sgpr 102
  .amdhsa_accum_offset 256
  .amdhsa_group_segment_fixed_size 0
  .amdhsa_kernarg_size 64
  .amdhsa_user_sgpr_count 2
  .amdhsa_user_sgpr_kernarg_segment_ptr 1
  .amdhsa_system_sgpr_workgroup_id_x 1
  .amdhsa_float_denorm_mode_32 3
  .amdhsa_float_denorm_mode_16_64 3
.end_amdhsa_kernel
```
